```python
import torch

def _softmax(x, axis=-1):
    return torch.softmax(x, dim=axis)
def _gelu(x):
    return torch.nn.functional.gelu(x, approximate="tanh")
def _silu(x):
    return torch.nn.functional.silu(x)
def _sigmoid(x):
    return torch.sigmoid(x)
def _layernorm(x, axis=-1, eps=1e-5):
    m = x.mean(dim=axis, keepdim=True)
    v = x.var(dim=axis, keepdim=True, unbiased=False)
    return (x - m) / torch.sqrt(v + eps)
def _scatter_add(tgt, idx, src, axis=0):
    return tgt.clone().index_add_(axis, idx, src)
def _segment_sum(src, seg, n):
    out = torch.zeros((n,) + src.shape[1:], dtype=src.dtype)
    return out.index_add_(0, seg, src)
def _pad(x, pw):
    flat = tuple(v for pair in reversed(pw) for v in pair)
    return torch.nn.functional.pad(x, flat)

kernel_name = 'recurrent_scan__spectral_fnet__geglu_ffn__prompt'

def setup_inputs():

    _w = (lambda a: (lambda t: t.to(torch.bfloat16) if t.is_floating_point() else t)(torch.as_tensor(a)))
    def _A_setup():
        B, S, D = 1, 2048, 512
        ns = torch.arange(S)[:, None] * torch.arange(S)[None, :]
        nd = torch.arange(D)[:, None] * torch.arange(D)[None, :]
        Ws_re = torch.cos(-2.0 * torch.pi * ns / S).to(float)
        Ws_im = torch.sin(-2.0 * torch.pi * ns / S).to(float)
        Wd_re = torch.cos(-2.0 * torch.pi * nd / D).to(float)
        Wd_im = torch.sin(-2.0 * torch.pi * nd / D).to(float)
        return {
            "x": _w((lambda *s: torch.randn(*s, dtype=torch.bfloat16) * 0.05)(B, S, D)),
            "dft_seq_re": _w(Ws_re),
            "dft_seq_im": _w(Ws_im),
            "dft_hid_re": _w(Wd_re),
            "dft_hid_im": _w(Wd_im),
        }
    _A_in = _A_setup()

    def _B_setup():
        B, S, D, F = 1, 2048, 512, 1376
        return {
            "x": _w((lambda *s: torch.randn(*s, dtype=torch.bfloat16) * 0.05)(B, S, D)),
            "w_gate": _w((lambda *s: torch.randn(*s, dtype=torch.bfloat16) * 0.05)(D, F)),
            "w_up": _w((lambda *s: torch.randn(*s, dtype=torch.bfloat16) * 0.05)(D, F)),
            "w_down": _w((lambda *s: torch.randn(*s, dtype=torch.bfloat16) * 0.05)(F, D)),
        }
    _B_in = _B_setup()

    return {
        "A_x": _A_in["x"],
        "A_dft_seq_re": _A_in["dft_seq_re"],
        "A_dft_seq_im": _A_in["dft_seq_im"],
        "A_dft_hid_re": _A_in["dft_hid_re"],
        "A_dft_hid_im": _A_in["dft_hid_im"],
        "B_x": _B_in["x"],
        "B_w_gate": _B_in["w_gate"],
        "B_w_up": _B_in["w_up"],
        "B_w_down": _B_in["w_down"],
    }

def reference(A_x, A_dft_seq_re, A_dft_seq_im, A_dft_hid_re, A_dft_hid_im, B_x, B_w_gate, B_w_up, B_w_down):
    def _A_ref(x, dft_seq_re, dft_seq_im, dft_hid_re, dft_hid_im):
        a = torch.einsum("bsd,ed->bse", x, dft_hid_re)
        b = torch.einsum("bsd,ed->bse", x, dft_hid_im)
        y = torch.einsum("ts,bse->bte", dft_seq_re, a) - torch.einsum("ts,bse->bte", dft_seq_im, b)
        return y

    def _B_ref(x, w_gate, w_up, w_down):
        return (_gelu(x @ w_gate) * (x @ w_up)) @ w_down

    x = A_x
    xn = _layernorm(x, axis=-1)
    s = _A_ref(xn, A_dft_seq_re, A_dft_seq_im, A_dft_hid_re, A_dft_hid_im)
    g = _silu(_B_ref(xn, B_w_gate, B_w_up, B_w_down))
    return x + s * g
```

```asm
; @launch grid=(256,1,1) block=(256,1,1) lds=163840
.amdgcn_target "amdgcn-amd-amdhsa--gfx950"
.text
    .globl recurrent_scan__spectral_fnet__geglu_ffn__prompt_kernel
    .p2align 12
    .type recurrent_scan__spectral_fnet__geglu_ffn__prompt_kernel,@function
recurrent_scan__spectral_fnet__geglu_ffn__prompt_kernel:
    s_cmp_ge_u32 s2, 256
    s_cbranch_scc0 L_go
    s_endpgm
L_go:
    s_load_dwordx2 s[8:9], s[0:1], 0
    s_load_dwordx2 s[12:13], s[0:1], 48
    s_load_dwordx2 s[16:17], s[0:1], 56
    s_load_dwordx2 s[20:21], s[0:1], 88
    s_load_dwordx2 s[24:25], s[0:1], 24
    s_load_dwordx2 s[28:29], s[0:1], 32
    s_load_dwordx2 s[4:5], s[0:1], 64
    s_getpc_b64 s[36:37]
L_pc:
    s_bfe_u32 s38, s2, 0x20003
    s_cmp_ge_u32 s38, 2
    s_cbranch_scc1 L_nopf
    s_lshl_b32 s38, s38, 15
    v_lshl_add_u32 v6, v0, 7, s38
    v_min_u32 v6, L_code_end-L_pc-4, v6
    global_load_dword a255, v6, s[36:37]
L_nopf:
    v_lshrrev_b32 v2, 6, v0
    v_and_b32 v1, 63, v0
    s_mov_b32 s10, 2097152
    s_mov_b32 s11, 0x20000
    v_readfirstlane_b32 s32, v2
    s_mov_b32 s14, 1409024
    s_mov_b32 s15, 0x20000
    s_mov_b32 s18, 1409024
    s_mov_b32 s19, 0x20000
    s_lshr_b32 s36, s2, 3
    s_and_b32 s33, s36, 7
    s_lshr_b32 s34, s36, 3
    s_add_u32 s37, s2, 5
    s_and_b32 s36, s37, 1
    s_lshl_b32 s36, s36, 3
    s_add_u32 s33, s33, s36
    s_and_b32 s36, s37, 6
    s_lshl_b32 s36, s36, 1
    s_add_u32 s34, s34, s36
    s_lshl_b32 s35, s33, 2
    s_add_u32 s35, s35, s32
    v_lshrrev_b32 v2, 3, v1
    v_and_b32 v3, 7, v1
    v_lshrrev_b32 v4, 4, v1
    v_xor_b32 v3, v3, v4
    v_lshlrev_b32 v3, 4, v3
    v_lshl_add_u32 v8, v2, 16, v3
    v_xor_b32 v9, 64, v8
    v_add_u32 v10, 1046528, v8
    v_add_u32 v11, 1569792, v9
    v_add_u32 v9, 523264, v9
    s_mov_b32 s39, 0x3f803f80
    s_cmp_lt_u32 s34, 14
    s_cbranch_scc1 K1_ffn
    s_sub_u32 s40, s34, 14
    s_mov_b32 s26, 524288
    s_mov_b32 s27, 0x20000
    s_mov_b32 s30, 524288
    s_mov_b32 s31, 0x20000
    s_lshl_b32 s36, s32, 6
    s_add_u32 s36, s36, s40
    v_lshlrev_b32 v4, 1, v2
    v_add_u32 v4, s36, v4
    v_lshl_add_u32 v14, v4, 10, v3
    v_cmp_eq_u32 vcc, 0, v4
    v_xor_b32 v13, 64, v14
    v_add_u32 v5, 262144, v14
    v_cndmask_b32 v12, v14, v5, vcc
    v_add_u32 v15, 46080, v13
    v_add_u32 v13, 15360, v13
    v_add_u32 v14, 30720, v14
    s_lshl_b32 s41, s35, 10
    s_add_u32 s45, s41, 512
    s_lshl_b32 s43, s32, 12
    s_lshl_b32 s44, s32, 13
    s_add_u32 s44, s44, 65536
    s_mov_b32 s52, 0
    s_waitcnt lgkmcnt(0)
    s_add_u32 m0, s43, 0
    s_add_u32 s38, s41, s52
    buffer_load_dwordx4 v8, s[8:11], s38 offen lds
    buffer_load_dwordx4 v9, s[8:11], s38 offen offset:1024 lds
    buffer_load_dwordx4 v10, s[8:11], s38 offen offset:2048 lds
    buffer_load_dwordx4 v11, s[8:11], s38 offen offset:3072 lds
    s_add_u32 m0, s43, 16384
    s_add_u32 s38, s45, s52
    buffer_load_dwordx4 v8, s[8:11], s38 offen lds
    buffer_load_dwordx4 v9, s[8:11], s38 offen offset:1024 lds
    buffer_load_dwordx4 v10, s[8:11], s38 offen offset:2048 lds
    buffer_load_dwordx4 v11, s[8:11], s38 offen offset:3072 lds
    s_add_u32 m0, s44, 0
    s_nop 0
    buffer_load_dwordx4 v12, s[24:27], s52 offen lds
    buffer_load_dwordx4 v13, s[24:27], s52 offen offset:1024 lds
    buffer_load_dwordx4 v14, s[24:27], s52 offen offset:2048 lds
    buffer_load_dwordx4 v15, s[24:27], s52 offen offset:3072 lds
    s_add_u32 m0, s44, 4096
    s_nop 0
    buffer_load_dwordx4 v12, s[28:31], s52 offen lds
    buffer_load_dwordx4 v13, s[28:31], s52 offen offset:1024 lds
    buffer_load_dwordx4 v14, s[28:31], s52 offen offset:2048 lds
    buffer_load_dwordx4 v15, s[28:31], s52 offen offset:3072 lds
    s_branch K1_dft_main
K1_ffn:
    s_mul_i32 s36, s32, 192
    s_mov_b32 s37, 0x15555556
    s_add_u32 s38, s36, 0
    v_add_u32 v4, s38, v1
    v_mul_hi_u32 v5, v4, s37
    v_lshlrev_b32 v4, 4, v4
    v_mul_u32_u24 v5, 2560, v5
    v_add_u32 v12, v4, v5
    s_add_u32 s38, s36, 64
    v_add_u32 v4, s38, v1
    v_mul_hi_u32 v5, v4, s37
    v_lshlrev_b32 v4, 4, v4
    v_mul_u32_u24 v5, 2560, v5
    v_add_u32 v13, v4, v5
    v_subrev_u32 v13, 1024, v13
    s_add_u32 s38, s36, 128
    v_add_u32 v4, s38, v1
    v_mul_hi_u32 v5, v4, s37
    v_lshlrev_b32 v4, 4, v4
    v_mul_u32_u24 v5, 2560, v5
    v_add_u32 v14, v4, v5
    v_subrev_u32 v14, 2048, v14
    s_add_u32 s61, s34, s33
    s_and_b32 s61, s61, 3
    s_lshl_b32 s59, s35, 10
    s_mul_i32 s60, s34, 192
    s_lshl_b32 s56, s32, 12
    s_mul_i32 s57, s32, 3072
    s_add_u32 s58, s57, 28704
    s_add_u32 s57, s57, 16384
    s_xor_b32 s36, s61, 0
    s_lshl_b32 s40, s36, 7
    s_add_u32 s40, s40, s59
    s_mul_i32 s48, s36, 176128
    s_add_u32 s48, s48, s60
    s_waitcnt lgkmcnt(0)
    s_add_u32 m0, s56, 0
    s_nop 0
    buffer_load_dwordx4 v8, s[8:11], s40 offen lds
    buffer_load_dwordx4 v9, s[8:11], s40 offen offset:1024 lds
    buffer_load_dwordx4 v10, s[8:11], s40 offen offset:2048 lds
    buffer_load_dwordx4 v11, s[8:11], s40 offen offset:3072 lds
    s_add_u32 m0, s57, 0
    s_nop 0
    buffer_load_dwordx4 v12, s[12:15], s48 offen lds
    buffer_load_dwordx4 v13, s[12:15], s48 offen offset:1024 lds
    buffer_load_dwordx4 v14, s[12:15], s48 offen offset:2048 lds
    s_add_u32 m0, s58, 0
    s_nop 0
    buffer_load_dwordx4 v12, s[16:19], s48 offen lds
    buffer_load_dwordx4 v13, s[16:19], s48 offen offset:1024 lds
    buffer_load_dwordx4 v14, s[16:19], s48 offen offset:2048 lds
    s_mov_b32 s22, 9437184
    s_mov_b32 s23, 0x20000
    s_mov_b32 s36, 8921088
    buffer_load_dword v6, off, s[20:23], s36 sc1
    s_xor_b32 s36, s61, 1
    s_lshl_b32 s41, s36, 7
    s_add_u32 s41, s41, s59
    s_mul_i32 s49, s36, 176128
    s_add_u32 s49, s49, s60
    s_add_u32 m0, s56, 41024
    s_nop 0
    buffer_load_dwordx4 v8, s[8:11], s41 offen lds
    buffer_load_dwordx4 v9, s[8:11], s41 offen offset:1024 lds
    buffer_load_dwordx4 v10, s[8:11], s41 offen offset:2048 lds
    buffer_load_dwordx4 v11, s[8:11], s41 offen offset:3072 lds
    s_add_u32 m0, s57, 41024
    s_nop 0
    buffer_load_dwordx4 v12, s[12:15], s49 offen lds
    buffer_load_dwordx4 v13, s[12:15], s49 offen offset:1024 lds
    buffer_load_dwordx4 v14, s[12:15], s49 offen offset:2048 lds
    s_add_u32 m0, s58, 41024
    s_nop 0
    buffer_load_dwordx4 v12, s[16:19], s49 offen lds
    buffer_load_dwordx4 v13, s[16:19], s49 offen offset:1024 lds
    buffer_load_dwordx4 v14, s[16:19], s49 offen offset:2048 lds
    s_xor_b32 s36, s61, 2
    s_lshl_b32 s42, s36, 7
    s_add_u32 s42, s42, s59
    s_mul_i32 s50, s36, 176128
    s_add_u32 s50, s50, s60
    s_xor_b32 s36, s61, 3
    s_lshl_b32 s43, s36, 7
    s_add_u32 s43, s43, s59
    s_mul_i32 s51, s36, 176128
    s_add_u32 s51, s51, s60
    s_xor_b32 s36, s61, 4
    s_lshl_b32 s44, s36, 7
    s_add_u32 s44, s44, s59
    s_mul_i32 s52, s36, 176128
    s_add_u32 s52, s52, s60
    s_xor_b32 s36, s61, 5
    s_lshl_b32 s45, s36, 7
    s_add_u32 s45, s45, s59
    s_mul_i32 s53, s36, 176128
    s_add_u32 s53, s53, s60
    s_xor_b32 s36, s61, 6
    s_lshl_b32 s46, s36, 7
    s_add_u32 s46, s46, s59
    s_mul_i32 s54, s36, 176128
    s_add_u32 s54, s54, s60
    s_xor_b32 s36, s61, 7
    s_lshl_b32 s47, s36, 7
    s_add_u32 s47, s47, s59
    s_mul_i32 s55, s36, 176128
    s_add_u32 s55, s55, s60
    v_and_b32 v2, 31, v1
    v_lshrrev_b32 v3, 5, v1
    v_bfe_u32 v4, v1, 1, 3
    v_xor_b32 v4, v4, v3
    v_lshlrev_b32 v4, 4, v4
    v_lshl_add_u32 v4, v2, 7, v4
    s_lshr_b32 s36, s32, 1
    s_lshl_b32 s36, s36, 13
    s_lshl_b32 s37, s32, 5
    s_add_u32 s36, s36, s37
    v_xor_b32 v16, s36, v4
    v_xor_b32 v17, 32, v16
    v_xor_b32 v18, 64, v16
    v_xor_b32 v19, 96, v16
    v_bfe_u32 v2, v1, 2, 2
    v_lshl_add_u32 v2, v3, 3, v2
    v_mul_u32_u24 v2, 192, v2
    v_and_b32 v4, 3, v1
    v_lshl_add_u32 v2, v4, 3, v2
    v_bfe_u32 v4, v1, 4, 1
    v_mul_u32_u24 v4, 12320, v4
    v_add_u32 v2, v2, v4
    s_and_b32 s37, s32, 1
    s_mul_i32 s37, s37, 96
    s_add_u32 s37, s37, 16384
    s_xor_b32 s36, s32, 0
    s_mul_i32 s36, s36, 3072
    s_add_u32 s36, s36, s37
    v_add_u32 v20, s36, v2
    s_xor_b32 s36, s32, 1
    s_mul_i32 s36, s36, 3072
    s_add_u32 s36, s36, s37
    v_add_u32 v21, s36, v2
    s_xor_b32 s36, s32, 2
    s_mul_i32 s36, s36, 3072
    s_add_u32 s36, s36, s37
    v_add_u32 v22, s36, v2
    s_xor_b32 s36, s32, 3
    s_mul_i32 s36, s36, 3072
    s_add_u32 s36, s36, s37
    v_add_u32 v23, s36, v2
    v_add_u32 v248, 82048, v16
    v_add_u32 v249, 82048, v17
    v_add_u32 v250, 82048, v18
    v_add_u32 v251, 82048, v19
    v_add_u32 v252, 82048, v20
    v_add_u32 v253, 82048, v21
    v_add_u32 v254, 82048, v22
    v_add_u32 v255, 82048, v23
    v_and_b32 v4, 31, v1
    v_mov_b32 v33, s39
    v_cmp_eq_u32 vcc, 0, v4
    v_cmp_eq_u32 s[62:63], 20, v4
    s_nop 0
    s_or_b64 vcc, vcc, s[62:63]
    s_nop 1
    v_cndmask_b32 v32, 0, v33, vcc
    v_mov_b32 v33, v32
    v_mov_b32 v34, v32
    v_mov_b32 v35, v32
    s_mov_b32 s6, 1409024
    s_mov_b32 s7, 0x20000
    s_bfe_u32 s99, s2, 0x20003
    s_and_b32 s36, s2, 7
    s_lshl_b32 s36, s36, 2
    s_add_u32 s99, s99, s36
    s_lshr_b32 s100, s2, 5
    s_lshr_b32 s36, s32, 1
    s_and_b32 s37, s32, 1
    s_mul_i32 s92, s36, 720896
    s_lshl_b32 s38, s37, 15
    s_add_u32 s92, s92, s38
    s_lshl_b32 s38, s100, 7
    s_add_u32 s92, s92, s38
    s_lshl_b32 s93, s36, 13
    s_lshl_b32 s38, s37, 12
    s_add_u32 s93, s93, s38
    s_and_b32 s94, s100, 3
    s_lshl_b32 s98, s33, 7
    s_lshl_b32 s38, s34, 2
    s_add_u32 s98, s98, s38
    s_add_u32 s98, s98, 8912896
    s_lshr_b32 s3, s2, 3
    s_mul_i32 s3, s3, 44032
    s_lshl_b32 s38, s32, 8
    s_add_u32 s3, s3, s38
    v_lshlrev_b32 v7, 10, v1
    v_cmp_gt_u32 vcc, 22, v1
    s_nop 1
    v_cndmask_b32 v7, -1, v7, vcc
    v_mov_b32 v26, 0
    v_mov_b32 v27, 0
    s_and_b32 s36, s35, -2
    s_mul_i32 s59, s36, 86
    s_mul_i32 s36, s34, 6
    s_add_u32 s59, s59, s36
    s_and_b32 s36, s32, 1
    s_mul_i32 s36, s36, 3
    s_add_u32 s59, s59, s36
    s_lshl_b32 s59, s59, 10
    s_add_u32 s60, s59, 88064
    v_lshlrev_b32 v2, 4, v1
    s_lshl_b32 s36, s32, 11
    s_add_u32 s36, s36, 155648
    v_add_u32 v3, s36, v2
    v_xor_b32 v4, 2048, v3
    v_xor_b32 v5, 4096, v3
    s_waitcnt vmcnt(11)
    s_barrier
    ds_read_b128 v[36:39], v16 offset:0
    ds_read_b64_tr_b16 v[68:69], v20 offset:0
    ds_read_b64_tr_b16 v[70:71], v20 offset:768
    ds_read_b128 v[40:43], v16 offset:4096
    ds_read_b64_tr_b16 v[72:73], v20 offset:32
    ds_read_b64_tr_b16 v[74:75], v20 offset:800
    ds_read_b64_tr_b16 v[76:77], v20 offset:64
    ds_read_b64_tr_b16 v[78:79], v20 offset:832
    s_waitcnt lgkmcnt(2)
    v_mfma_f32_32x32x16_bf16 v[104:119], v[68:71], v[36:39], 0
    ds_read_b128 v[44:47], v17 offset:0
    s_add_u32 m0, s56, 82048
    ds_read_b64_tr_b16 v[80:81], v21 offset:0
    ds_read_b64_tr_b16 v[82:83], v21 offset:768
    ds_read_b128 v[48:51], v17 offset:4096
    v_mfma_f32_32x32x16_bf16 v[120:135], v[68:71], v[40:43], 0
    buffer_load_dwordx4 v8, s[8:11], s42 offen lds
    ds_read_b64_tr_b16 v[84:85], v21 offset:32
    ds_read_b64_tr_b16 v[86:87], v21 offset:800
    ds_read_b64_tr_b16 v[88:89], v21 offset:64
    v_mfma_f32_16x16x32_bf16 v[92:95], v[32:35], v[68:71], 0
    buffer_load_dwordx4 v9, s[8:11], s42 offen offset:1024 lds
    v_mfma_f32_32x32x16_bf16 v[136:151], v[72:75], v[36:39], 0
    ds_read_b64_tr_b16 v[90:91], v21 offset:832
    v_lshlrev_b32 v28, 16, v36
    v_and_b32 v29, 0xffff0000, v36
    v_fmac_f32 v26, v28, v28
    v_fmac_f32 v26, v29, v29
    v_mfma_f32_16x16x32_bf16 v[240:243], v[32:35], v[36:39], 0
    v_lshlrev_b32 v30, 16, v37
    v_mfma_f32_32x32x16_bf16 v[152:167], v[72:75], v[40:43], 0
    buffer_load_dwordx4 v10, s[8:11], s42 offen offset:2048 lds
    v_and_b32 v31, 0xffff0000, v37
    v_fmac_f32 v26, v30, v30
    v_fmac_f32 v26, v31, v31
    v_mfma_f32_16x16x32_bf16 v[96:99], v[32:35], v[72:75], 0
    s_waitcnt lgkmcnt(8)
    v_mfma_f32_32x32x16_bf16 v[168:183], v[76:79], v[36:39], 0
    buffer_load_dwordx4 v11, s[8:11], s42 offen offset:3072 lds
    v_lshlrev_b32 v28, 16, v38
    v_and_b32 v29, 0xffff0000, v38
    v_fmac_f32 v26, v28, v28
    v_mfma_f32_32x32x16_bf16 v[184:199], v[76:79], v[40:43], 0
    v_fmac_f32 v26, v29, v29
    v_lshlrev_b32 v30, 16, v39
    v_and_b32 v31, 0xffff0000, v39
    v_fmac_f32 v26, v30, v30
    v_fmac_f32 v26, v31, v31
    v_mfma_f32_16x16x32_bf16 v[100:103], v[32:35], v[76:79], 0
    s_waitcnt lgkmcnt(2)
    v_mfma_f32_32x32x16_bf16 v[104:119], v[80:83], v[44:47], v[104:119]
    ds_read_b128 v[52:55], v18 offset:0
    s_add_u32 m0, s57, 82048
    ds_read_b64_tr_b16 v[68:69], v22 offset:0
    ds_read_b64_tr_b16 v[70:71], v22 offset:768
    ds_read_b128 v[56:59], v18 offset:4096
    v_mfma_f32_32x32x16_bf16 v[120:135], v[80:83], v[48:51], v[120:135]
    buffer_load_dwordx4 v12, s[12:15], s50 offen lds
    ds_read_b64_tr_b16 v[72:73], v22 offset:32
    ds_read_b64_tr_b16 v[74:75], v22 offset:800
    ds_read_b64_tr_b16 v[76:77], v22 offset:64
    v_mfma_f32_16x16x32_bf16 v[92:95], v[32:35], v[80:83], v[92:95]
    ds_read_b64_tr_b16 v[78:79], v22 offset:832
    v_mfma_f32_32x32x16_bf16 v[136:151], v[84:87], v[44:47], v[136:151]
    buffer_load_dwordx4 v13, s[12:15], s50 offen offset:1024 lds
    v_lshlrev_b32 v28, 16, v40
    v_and_b32 v29, 0xffff0000, v40
    v_fmac_f32 v27, v28, v28
    v_mfma_f32_16x16x32_bf16 v[244:247], v[32:35], v[40:43], 0
    v_fmac_f32 v27, v29, v29
    v_mfma_f32_32x32x16_bf16 v[152:167], v[84:87], v[48:51], v[152:167]
    buffer_load_dwordx4 v14, s[12:15], s50 offen offset:2048 lds
    v_lshlrev_b32 v30, 16, v41
    v_and_b32 v31, 0xffff0000, v41
    v_fmac_f32 v27, v30, v30
    v_mfma_f32_16x16x32_bf16 v[96:99], v[32:35], v[84:87], v[96:99]
    s_waitcnt lgkmcnt(8)
    v_mfma_f32_32x32x16_bf16 v[168:183], v[88:91], v[44:47], v[168:183]
    s_add_u32 m0, s58, 82048
    v_fmac_f32 v27, v31, v31
    v_lshlrev_b32 v28, 16, v42
    v_and_b32 v29, 0xffff0000, v42
    v_fmac_f32 v27, v28, v28
    v_mfma_f32_32x32x16_bf16 v[184:199], v[88:91], v[48:51], v[184:199]
    buffer_load_dwordx4 v12, s[16:19], s50 offen lds
    v_fmac_f32 v27, v29, v29
    v_lshlrev_b32 v30, 16, v43
    v_and_b32 v31, 0xffff0000, v43
    v_mfma_f32_16x16x32_bf16 v[100:103], v[32:35], v[88:91], v[100:103]
    s_waitcnt lgkmcnt(2)
    v_mfma_f32_32x32x16_bf16 v[104:119], v[68:71], v[52:55], v[104:119]
    buffer_load_dwordx4 v13, s[16:19], s50 offen offset:1024 lds
    ds_read_b128 v[60:63], v19 offset:0
    ds_read_b64_tr_b16 v[80:81], v23 offset:0
    ds_read_b64_tr_b16 v[82:83], v23 offset:768
    v_mfma_f32_32x32x16_bf16 v[120:135], v[68:71], v[56:59], v[120:135]
    ds_read_b128 v[64:67], v19 offset:4096
    ds_read_b64_tr_b16 v[84:85], v23 offset:32
    ds_read_b64_tr_b16 v[86:87], v23 offset:800
    ds_read_b64_tr_b16 v[88:89], v23 offset:64
    ds_read_b64_tr_b16 v[90:91], v23 offset:832
    v_mfma_f32_32x32x16_bf16 v[136:151], v[72:75], v[52:55], v[136:151]
    v_fmac_f32 v27, v30, v30
    v_fmac_f32 v27, v31, v31
    v_lshlrev_b32 v28, 16, v52
    v_and_b32 v29, 0xffff0000, v52
    v_fmac_f32 v26, v28, v28
    v_mfma_f32_32x32x16_bf16 v[152:167], v[72:75], v[56:59], v[152:167]
    buffer_load_dwordx4 v14, s[16:19], s50 offen offset:2048 lds
    v_fmac_f32 v26, v29, v29
    v_lshlrev_b32 v30, 16, v53
    v_and_b32 v31, 0xffff0000, v53
    v_mfma_f32_16x16x32_bf16 v[240:243], v[32:35], v[52:55], v[240:243]
    s_waitcnt lgkmcnt(8)
    v_mfma_f32_32x32x16_bf16 v[168:183], v[76:79], v[52:55], v[168:183]
    v_fmac_f32 v26, v30, v30
    v_fmac_f32 v26, v31, v31
    v_lshlrev_b32 v28, 16, v54
    v_and_b32 v29, 0xffff0000, v54
    v_fmac_f32 v26, v28, v28
    v_mfma_f32_32x32x16_bf16 v[184:199], v[76:79], v[56:59], v[184:199]
    v_fmac_f32 v26, v29, v29
    v_lshlrev_b32 v30, 16, v55
    v_and_b32 v31, 0xffff0000, v55
    v_fmac_f32 v26, v30, v30
    s_waitcnt lgkmcnt(2)
    v_mfma_f32_32x32x16_bf16 v[104:119], v[80:83], v[60:63], v[104:119]
    v_fmac_f32 v26, v31, v31
    v_lshlrev_b32 v28, 16, v56
    v_and_b32 v29, 0xffff0000, v56
    s_waitcnt vmcnt(10) lgkmcnt(0)
    s_barrier
    v_mfma_f32_32x32x16_bf16 v[120:135], v[80:83], v[64:67], v[120:135]
    ds_read_b128 v[36:39], v16 offset:41024
    ds_read_b64_tr_b16 v[68:69], v20 offset:41024
    ds_read_b64_tr_b16 v[70:71], v20 offset:41792
    s_add_u32 m0, s56, 0
    ds_read_b128 v[40:43], v16 offset:45120
    v_mfma_f32_32x32x16_bf16 v[136:151], v[84:87], v[60:63], v[136:151]
    buffer_load_dwordx4 v8, s[8:11], s43 offen lds
    ds_read_b64_tr_b16 v[72:73], v20 offset:41056
    ds_read_b64_tr_b16 v[74:75], v20 offset:41824
    ds_read_b64_tr_b16 v[76:77], v20 offset:41088
    v_mfma_f32_32x32x16_bf16 v[152:167], v[84:87], v[64:67], v[152:167]
    buffer_load_dwordx4 v9, s[8:11], s43 offen offset:1024 lds
    ds_read_b64_tr_b16 v[78:79], v20 offset:41856
    v_fmac_f32 v27, v28, v28
    v_fmac_f32 v27, v29, v29
    v_mfma_f32_16x16x32_bf16 v[244:247], v[32:35], v[56:59], v[244:247]
    v_lshlrev_b32 v30, 16, v57
    v_mfma_f32_32x32x16_bf16 v[168:183], v[88:91], v[60:63], v[168:183]
    v_and_b32 v31, 0xffff0000, v57
    v_fmac_f32 v27, v30, v30
    v_fmac_f32 v27, v31, v31
    v_lshlrev_b32 v28, 16, v58
    v_and_b32 v29, 0xffff0000, v58
    v_mfma_f32_32x32x16_bf16 v[184:199], v[88:91], v[64:67], v[184:199]
    buffer_load_dwordx4 v10, s[8:11], s43 offen offset:2048 lds
    v_fmac_f32 v27, v28, v28
    v_fmac_f32 v27, v29, v29
    s_waitcnt lgkmcnt(2)
    v_mfma_f32_32x32x16_bf16 v[104:119], v[68:71], v[36:39], v[104:119]
    ds_read_b128 v[44:47], v17 offset:41024
    ds_read_b64_tr_b16 v[80:81], v21 offset:41024
    ds_read_b64_tr_b16 v[82:83], v21 offset:41792
    ds_read_b128 v[48:51], v17 offset:45120
    ds_read_b64_tr_b16 v[84:85], v21 offset:41056
    v_mfma_f32_32x32x16_bf16 v[120:135], v[68:71], v[40:43], v[120:135]
    buffer_load_dwordx4 v11, s[8:11], s43 offen offset:3072 lds
    ds_read_b64_tr_b16 v[86:87], v21 offset:41824
    ds_read_b64_tr_b16 v[88:89], v21 offset:41088
    ds_read_b64_tr_b16 v[90:91], v21 offset:41856
    v_mfma_f32_16x16x32_bf16 v[92:95], v[32:35], v[68:71], v[92:95]
    v_lshlrev_b32 v30, 16, v59
    v_mfma_f32_32x32x16_bf16 v[136:151], v[72:75], v[36:39], v[136:151]
    s_add_u32 m0, s57, 0
    v_and_b32 v31, 0xffff0000, v59
    v_fmac_f32 v27, v30, v30
    v_fmac_f32 v27, v31, v31
    v_lshlrev_b32 v28, 16, v36
    v_mfma_f32_16x16x32_bf16 v[240:243], v[32:35], v[36:39], v[240:243]
    buffer_load_dwordx4 v12, s[12:15], s51 offen lds
    v_mfma_f32_32x32x16_bf16 v[152:167], v[72:75], v[40:43], v[152:167]
    v_and_b32 v29, 0xffff0000, v36
    v_fmac_f32 v26, v28, v28
    v_fmac_f32 v26, v29, v29
    v_lshlrev_b32 v30, 16, v37
    v_and_b32 v31, 0xffff0000, v37
    v_mfma_f32_16x16x32_bf16 v[96:99], v[32:35], v[72:75], v[96:99]
    s_waitcnt lgkmcnt(8)
    v_mfma_f32_32x32x16_bf16 v[168:183], v[76:79], v[36:39], v[168:183]
    buffer_load_dwordx4 v13, s[12:15], s51 offen offset:1024 lds
    v_fmac_f32 v26, v30, v30
    v_fmac_f32 v26, v31, v31
    v_lshlrev_b32 v28, 16, v38
    v_mfma_f32_32x32x16_bf16 v[184:199], v[76:79], v[40:43], v[184:199]
    v_and_b32 v29, 0xffff0000, v38
    v_fmac_f32 v26, v28, v28
    v_fmac_f32 v26, v29, v29
    v_lshlrev_b32 v30, 16, v39
    v_and_b32 v31, 0xffff0000, v39
    v_mfma_f32_16x16x32_bf16 v[100:103], v[32:35], v[76:79], v[100:103]
    s_waitcnt lgkmcnt(2)
    v_mfma_f32_32x32x16_bf16 v[104:119], v[80:83], v[44:47], v[104:119]
    buffer_load_dwordx4 v14, s[12:15], s51 offen offset:2048 lds
    ds_read_b128 v[52:55], v18 offset:41024
    ds_read_b64_tr_b16 v[68:69], v22 offset:41024
    ds_read_b64_tr_b16 v[70:71], v22 offset:41792
    v_mfma_f32_32x32x16_bf16 v[120:135], v[80:83], v[48:51], v[120:135]
    ds_read_b128 v[56:59], v18 offset:45120
    s_add_u32 m0, s58, 0
    ds_read_b64_tr_b16 v[72:73], v22 offset:41056
    ds_read_b64_tr_b16 v[74:75], v22 offset:41824
    ds_read_b64_tr_b16 v[76:77], v22 offset:41088
    v_mfma_f32_16x16x32_bf16 v[92:95], v[32:35], v[80:83], v[92:95]
    buffer_load_dwordx4 v12, s[16:19], s51 offen lds
    v_mfma_f32_32x32x16_bf16 v[136:151], v[84:87], v[44:47], v[136:151]
    ds_read_b64_tr_b16 v[78:79], v22 offset:41856
    v_fmac_f32 v26, v30, v30
    v_fmac_f32 v26, v31, v31
    v_lshlrev_b32 v28, 16, v40
    v_and_b32 v29, 0xffff0000, v40
    v_mfma_f32_16x16x32_bf16 v[244:247], v[32:35], v[40:43], v[244:247]
    buffer_load_dwordx4 v13, s[16:19], s51 offen offset:1024 lds
    v_mfma_f32_32x32x16_bf16 v[152:167], v[84:87], v[48:51], v[152:167]
    v_fmac_f32 v27, v28, v28
    v_fmac_f32 v27, v29, v29
    v_lshlrev_b32 v30, 16, v41
    v_and_b32 v31, 0xffff0000, v41
    v_fmac_f32 v27, v30, v30
    v_mfma_f32_16x16x32_bf16 v[96:99], v[32:35], v[84:87], v[96:99]
    s_waitcnt lgkmcnt(8)
    v_mfma_f32_32x32x16_bf16 v[168:183], v[88:91], v[44:47], v[168:183]
    buffer_load_dwordx4 v14, s[16:19], s51 offen offset:2048 lds
    v_fmac_f32 v27, v31, v31
    v_lshlrev_b32 v28, 16, v42
    v_and_b32 v29, 0xffff0000, v42
    v_mfma_f32_32x32x16_bf16 v[184:199], v[88:91], v[48:51], v[184:199]
    v_fmac_f32 v27, v28, v28
    v_fmac_f32 v27, v29, v29
    v_lshlrev_b32 v30, 16, v43
    v_and_b32 v31, 0xffff0000, v43
    v_fmac_f32 v27, v30, v30
    v_mfma_f32_16x16x32_bf16 v[100:103], v[32:35], v[88:91], v[100:103]
    s_waitcnt lgkmcnt(2)
    v_mfma_f32_32x32x16_bf16 v[104:119], v[68:71], v[52:55], v[104:119]
    ds_read_b128 v[60:63], v19 offset:41024
    ds_read_b64_tr_b16 v[80:81], v23 offset:41024
    ds_read_b64_tr_b16 v[82:83], v23 offset:41792
    ds_read_b128 v[64:67], v19 offset:45120
    ds_read_b64_tr_b16 v[84:85], v23 offset:41056
    v_mfma_f32_32x32x16_bf16 v[120:135], v[68:71], v[56:59], v[120:135]
    ds_read_b64_tr_b16 v[86:87], v23 offset:41824
    ds_read_b64_tr_b16 v[88:89], v23 offset:41088
    ds_read_b64_tr_b16 v[90:91], v23 offset:41856
    v_fmac_f32 v27, v31, v31
    v_lshlrev_b32 v28, 16, v52
    v_mfma_f32_32x32x16_bf16 v[136:151], v[72:75], v[52:55], v[136:151]
    v_readfirstlane_b32 s95, v6
    s_nop 0
    s_add_u32 s95, s95, 1
    v_and_b32 v29, 0xffff0000, v52
    v_fmac_f32 v26, v28, v28
    v_mfma_f32_32x32x16_bf16 v[152:167], v[72:75], v[56:59], v[152:167]
    v_fmac_f32 v26, v29, v29
    v_lshlrev_b32 v30, 16, v53
    v_and_b32 v31, 0xffff0000, v53
    v_fmac_f32 v26, v30, v30
    v_fmac_f32 v26, v31, v31
    v_mfma_f32_16x16x32_bf16 v[240:243], v[32:35], v[52:55], v[240:243]
    s_waitcnt lgkmcnt(8)
    v_mfma_f32_32x32x16_bf16 v[168:183], v[76:79], v[52:55], v[168:183]
    v_lshlrev_b32 v28, 16, v54
    v_and_b32 v29, 0xffff0000, v54
    v_fmac_f32 v26, v28, v28
    v_fmac_f32 v26, v29, v29
    v_lshlrev_b32 v30, 16, v55
    v_mfma_f32_32x32x16_bf16 v[184:199], v[76:79], v[56:59], v[184:199]
    v_and_b32 v31, 0xffff0000, v55
    v_fmac_f32 v26, v30, v30
    v_fmac_f32 v26, v31, v31
    v_lshlrev_b32 v28, 16, v56
    s_waitcnt lgkmcnt(2)
    v_mfma_f32_32x32x16_bf16 v[104:119], v[80:83], v[60:63], v[104:119]
    v_and_b32 v29, 0xffff0000, v56
    v_fmac_f32 v27, v28, v28
    v_fmac_f32 v27, v29, v29
    s_waitcnt vmcnt(10) lgkmcnt(0)
    s_barrier
    v_mfma_f32_32x32x16_bf16 v[120:135], v[80:83], v[64:67], v[120:135]
    ds_read_b128 v[36:39], v248 offset:0
    ds_read_b64_tr_b16 v[68:69], v252 offset:0
    ds_read_b64_tr_b16 v[70:71], v252 offset:768
    s_add_u32 m0, s56, 41024
    ds_read_b128 v[40:43], v248 offset:4096
    v_mfma_f32_32x32x16_bf16 v[136:151], v[84:87], v[60:63], v[136:151]
    buffer_load_dwordx4 v8, s[8:11], s44 offen lds
    ds_read_b64_tr_b16 v[72:73], v252 offset:32
    ds_read_b64_tr_b16 v[74:75], v252 offset:800
    ds_read_b64_tr_b16 v[76:77], v252 offset:64
    v_mfma_f32_32x32x16_bf16 v[152:167], v[84:87], v[64:67], v[152:167]
    buffer_load_dwordx4 v9, s[8:11], s44 offen offset:1024 lds
    ds_read_b64_tr_b16 v[78:79], v252 offset:832
    v_lshlrev_b32 v30, 16, v57
    v_and_b32 v31, 0xffff0000, v57
    v_mfma_f32_16x16x32_bf16 v[244:247], v[32:35], v[56:59], v[244:247]
    v_fmac_f32 v27, v30, v30
    v_mfma_f32_32x32x16_bf16 v[168:183], v[88:91], v[60:63], v[168:183]
    v_fmac_f32 v27, v31, v31
    v_lshlrev_b32 v28, 16, v58
    v_and_b32 v29, 0xffff0000, v58
    v_fmac_f32 v27, v28, v28
    v_fmac_f32 v27, v29, v29
    v_mfma_f32_32x32x16_bf16 v[184:199], v[88:91], v[64:67], v[184:199]
    buffer_load_dwordx4 v10, s[8:11], s44 offen offset:2048 lds
    v_lshlrev_b32 v30, 16, v59
    v_and_b32 v31, 0xffff0000, v59
    s_waitcnt lgkmcnt(2)
    v_mfma_f32_32x32x16_bf16 v[104:119], v[68:71], v[36:39], v[104:119]
    ds_read_b128 v[44:47], v249 offset:0
    ds_read_b64_tr_b16 v[80:81], v253 offset:0
    ds_read_b64_tr_b16 v[82:83], v253 offset:768
    ds_read_b128 v[48:51], v249 offset:4096
    ds_read_b64_tr_b16 v[84:85], v253 offset:32
    v_mfma_f32_32x32x16_bf16 v[120:135], v[68:71], v[40:43], v[120:135]
    buffer_load_dwordx4 v11, s[8:11], s44 offen offset:3072 lds
    ds_read_b64_tr_b16 v[86:87], v253 offset:800
    ds_read_b64_tr_b16 v[88:89], v253 offset:64
    ds_read_b64_tr_b16 v[90:91], v253 offset:832
    v_mfma_f32_16x16x32_bf16 v[92:95], v[32:35], v[68:71], v[92:95]
    v_fmac_f32 v27, v30, v30
    v_mfma_f32_32x32x16_bf16 v[136:151], v[72:75], v[36:39], v[136:151]
    s_add_u32 m0, s57, 41024
    v_fmac_f32 v27, v31, v31
    v_lshlrev_b32 v28, 16, v36
    v_and_b32 v29, 0xffff0000, v36
    v_fmac_f32 v26, v28, v28
    v_mfma_f32_16x16x32_bf16 v[240:243], v[32:35], v[36:39], v[240:243]
    buffer_load_dwordx4 v12, s[12:15], s52 offen lds
    v_mfma_f32_32x32x16_bf16 v[152:167], v[72:75], v[40:43], v[152:167]
    v_fmac_f32 v26, v29, v29
    v_lshlrev_b32 v30, 16, v37
    v_and_b32 v31, 0xffff0000, v37
    v_fmac_f32 v26, v30, v30
    v_fmac_f32 v26, v31, v31
    v_mfma_f32_16x16x32_bf16 v[96:99], v[32:35], v[72:75], v[96:99]
    s_waitcnt lgkmcnt(8)
    v_mfma_f32_32x32x16_bf16 v[168:183], v[76:79], v[36:39], v[168:183]
    buffer_load_dwordx4 v13, s[12:15], s52 offen offset:1024 lds
    v_lshlrev_b32 v28, 16, v38
    v_and_b32 v29, 0xffff0000, v38
    v_fmac_f32 v26, v28, v28
    v_mfma_f32_32x32x16_bf16 v[184:199], v[76:79], v[40:43], v[184:199]
    v_fmac_f32 v26, v29, v29
    v_lshlrev_b32 v30, 16, v39
    v_and_b32 v31, 0xffff0000, v39
    v_fmac_f32 v26, v30, v30
    v_fmac_f32 v26, v31, v31
    v_mfma_f32_16x16x32_bf16 v[100:103], v[32:35], v[76:79], v[100:103]
    s_waitcnt lgkmcnt(2)
    v_mfma_f32_32x32x16_bf16 v[104:119], v[80:83], v[44:47], v[104:119]
    buffer_load_dwordx4 v14, s[12:15], s52 offen offset:2048 lds
    ds_read_b128 v[52:55], v250 offset:0
    ds_read_b64_tr_b16 v[68:69], v254 offset:0
    ds_read_b64_tr_b16 v[70:71], v254 offset:768
    v_mfma_f32_32x32x16_bf16 v[120:135], v[80:83], v[48:51], v[120:135]
    ds_read_b128 v[56:59], v250 offset:4096
    s_add_u32 m0, s58, 41024
    ds_read_b64_tr_b16 v[72:73], v254 offset:32
    ds_read_b64_tr_b16 v[74:75], v254 offset:800
    ds_read_b64_tr_b16 v[76:77], v254 offset:64
    v_mfma_f32_16x16x32_bf16 v[92:95], v[32:35], v[80:83], v[92:95]
    buffer_load_dwordx4 v12, s[16:19], s52 offen lds
    v_mfma_f32_32x32x16_bf16 v[136:151], v[84:87], v[44:47], v[136:151]
    ds_read_b64_tr_b16 v[78:79], v254 offset:832
    v_lshlrev_b32 v28, 16, v40
    v_and_b32 v29, 0xffff0000, v40
    v_fmac_f32 v27, v28, v28
    v_fmac_f32 v27, v29, v29
    v_mfma_f32_16x16x32_bf16 v[244:247], v[32:35], v[40:43], v[244:247]
    buffer_load_dwordx4 v13, s[16:19], s52 offen offset:1024 lds
    v_mfma_f32_32x32x16_bf16 v[152:167], v[84:87], v[48:51], v[152:167]
    v_lshlrev_b32 v30, 16, v41
    v_and_b32 v31, 0xffff0000, v41
    v_fmac_f32 v27, v30, v30
    v_fmac_f32 v27, v31, v31
    v_lshlrev_b32 v28, 16, v42
    v_mfma_f32_16x16x32_bf16 v[96:99], v[32:35], v[84:87], v[96:99]
    s_waitcnt lgkmcnt(8)
    v_mfma_f32_32x32x16_bf16 v[168:183], v[88:91], v[44:47], v[168:183]
    buffer_load_dwordx4 v14, s[16:19], s52 offen offset:2048 lds
    v_and_b32 v29, 0xffff0000, v42
    v_fmac_f32 v27, v28, v28
    v_fmac_f32 v27, v29, v29
    v_mfma_f32_32x32x16_bf16 v[184:199], v[88:91], v[48:51], v[184:199]
    v_lshlrev_b32 v30, 16, v43
    v_and_b32 v31, 0xffff0000, v43
    v_fmac_f32 v27, v30, v30
    v_fmac_f32 v27, v31, v31
    v_mfma_f32_16x16x32_bf16 v[100:103], v[32:35], v[88:91], v[100:103]
    s_waitcnt lgkmcnt(2)
    v_mfma_f32_32x32x16_bf16 v[104:119], v[68:71], v[52:55], v[104:119]
    ds_read_b128 v[60:63], v251 offset:0
    ds_read_b64_tr_b16 v[80:81], v255 offset:0
    ds_read_b64_tr_b16 v[82:83], v255 offset:768
    ds_read_b128 v[64:67], v251 offset:4096
    ds_read_b64_tr_b16 v[84:85], v255 offset:32
    v_mfma_f32_32x32x16_bf16 v[120:135], v[68:71], v[56:59], v[120:135]
    ds_read_b64_tr_b16 v[86:87], v255 offset:800
    ds_read_b64_tr_b16 v[88:89], v255 offset:64
    ds_read_b64_tr_b16 v[90:91], v255 offset:832
    v_lshlrev_b32 v28, 16, v52
    v_and_b32 v29, 0xffff0000, v52
    v_mfma_f32_32x32x16_bf16 v[136:151], v[72:75], v[52:55], v[136:151]
    v_fmac_f32 v26, v28, v28
    v_fmac_f32 v26, v29, v29
    v_lshlrev_b32 v30, 16, v53
    v_and_b32 v31, 0xffff0000, v53
    v_fmac_f32 v26, v30, v30
    v_mfma_f32_32x32x16_bf16 v[152:167], v[72:75], v[56:59], v[152:167]
    v_fmac_f32 v26, v31, v31
    v_lshlrev_b32 v28, 16, v54
    v_and_b32 v29, 0xffff0000, v54
    v_fmac_f32 v26, v28, v28
    v_fmac_f32 v26, v29, v29
    v_mfma_f32_16x16x32_bf16 v[240:243], v[32:35], v[52:55], v[240:243]
    s_waitcnt lgkmcnt(8)
    v_mfma_f32_32x32x16_bf16 v[168:183], v[76:79], v[52:55], v[168:183]
    v_lshlrev_b32 v30, 16, v55
    v_and_b32 v31, 0xffff0000, v55
    v_fmac_f32 v26, v30, v30
    v_fmac_f32 v26, v31, v31
    v_lshlrev_b32 v28, 16, v56
    v_mfma_f32_32x32x16_bf16 v[184:199], v[76:79], v[56:59], v[184:199]
    v_and_b32 v29, 0xffff0000, v56
    v_fmac_f32 v27, v28, v28
    v_fmac_f32 v27, v29, v29
    v_lshlrev_b32 v30, 16, v57
    s_waitcnt lgkmcnt(2)
    v_mfma_f32_32x32x16_bf16 v[104:119], v[80:83], v[60:63], v[104:119]
    v_and_b32 v31, 0xffff0000, v57
    v_fmac_f32 v27, v30, v30
    v_fmac_f32 v27, v31, v31
    s_waitcnt vmcnt(10) lgkmcnt(0)
    s_barrier
    v_mfma_f32_32x32x16_bf16 v[120:135], v[80:83], v[64:67], v[120:135]
    ds_read_b128 v[36:39], v16 offset:0
    ds_read_b64_tr_b16 v[68:69], v20 offset:0
    ds_read_b64_tr_b16 v[70:71], v20 offset:768
    s_add_u32 m0, s56, 82048
    ds_read_b128 v[40:43], v16 offset:4096
    v_mfma_f32_32x32x16_bf16 v[136:151], v[84:87], v[60:63], v[136:151]
    buffer_load_dwordx4 v8, s[8:11], s45 offen lds
    ds_read_b64_tr_b16 v[72:73], v20 offset:32
    ds_read_b64_tr_b16 v[74:75], v20 offset:800
    ds_read_b64_tr_b16 v[76:77], v20 offset:64
    v_mfma_f32_32x32x16_bf16 v[152:167], v[84:87], v[64:67], v[152:167]
    buffer_load_dwordx4 v9, s[8:11], s45 offen offset:1024 lds
    ds_read_b64_tr_b16 v[78:79], v20 offset:832
    v_lshlrev_b32 v28, 16, v58
    v_and_b32 v29, 0xffff0000, v58
    v_mfma_f32_16x16x32_bf16 v[244:247], v[32:35], v[56:59], v[244:247]
    v_fmac_f32 v27, v28, v28
    v_mfma_f32_32x32x16_bf16 v[168:183], v[88:91], v[60:63], v[168:183]
    v_fmac_f32 v27, v29, v29
    v_lshlrev_b32 v30, 16, v59
    v_and_b32 v31, 0xffff0000, v59
    v_fmac_f32 v27, v30, v30
    v_fmac_f32 v27, v31, v31
    v_mfma_f32_32x32x16_bf16 v[184:199], v[88:91], v[64:67], v[184:199]
    buffer_load_dwordx4 v10, s[8:11], s45 offen offset:2048 lds
    s_waitcnt lgkmcnt(2)
    v_mfma_f32_32x32x16_bf16 v[104:119], v[68:71], v[36:39], v[104:119]
    ds_read_b128 v[44:47], v17 offset:0
    ds_read_b64_tr_b16 v[80:81], v21 offset:0
    ds_read_b64_tr_b16 v[82:83], v21 offset:768
    ds_read_b128 v[48:51], v17 offset:4096
    ds_read_b64_tr_b16 v[84:85], v21 offset:32
    v_mfma_f32_32x32x16_bf16 v[120:135], v[68:71], v[40:43], v[120:135]
    buffer_load_dwordx4 v11, s[8:11], s45 offen offset:3072 lds
    ds_read_b64_tr_b16 v[86:87], v21 offset:800
    ds_read_b64_tr_b16 v[88:89], v21 offset:64
    ds_read_b64_tr_b16 v[90:91], v21 offset:832
    v_mfma_f32_16x16x32_bf16 v[92:95], v[32:35], v[68:71], v[92:95]
    v_lshlrev_b32 v28, 16, v36
    v_mfma_f32_32x32x16_bf16 v[136:151], v[72:75], v[36:39], v[136:151]
    s_add_u32 m0, s57, 82048
    v_and_b32 v29, 0xffff0000, v36
    v_fmac_f32 v26, v28, v28
    v_fmac_f32 v26, v29, v29
    v_lshlrev_b32 v30, 16, v37
    v_mfma_f32_16x16x32_bf16 v[240:243], v[32:35], v[36:39], v[240:243]
    buffer_load_dwordx4 v12, s[12:15], s53 offen lds
    v_mfma_f32_32x32x16_bf16 v[152:167], v[72:75], v[40:43], v[152:167]
    v_and_b32 v31, 0xffff0000, v37
    v_fmac_f32 v26, v30, v30
    v_fmac_f32 v26, v31, v31
    v_lshlrev_b32 v28, 16, v38
    v_and_b32 v29, 0xffff0000, v38
    v_mfma_f32_16x16x32_bf16 v[96:99], v[32:35], v[72:75], v[96:99]
    s_waitcnt lgkmcnt(8)
    v_mfma_f32_32x32x16_bf16 v[168:183], v[76:79], v[36:39], v[168:183]
    buffer_load_dwordx4 v13, s[12:15], s53 offen offset:1024 lds
    v_fmac_f32 v26, v28, v28
    v_fmac_f32 v26, v29, v29
    v_lshlrev_b32 v30, 16, v39
    v_mfma_f32_32x32x16_bf16 v[184:199], v[76:79], v[40:43], v[184:199]
    v_and_b32 v31, 0xffff0000, v39
    v_fmac_f32 v26, v30, v30
    v_fmac_f32 v26, v31, v31
    v_lshlrev_b32 v28, 16, v40
    v_and_b32 v29, 0xffff0000, v40
    v_mfma_f32_16x16x32_bf16 v[100:103], v[32:35], v[76:79], v[100:103]
    s_waitcnt lgkmcnt(2)
    v_mfma_f32_32x32x16_bf16 v[104:119], v[80:83], v[44:47], v[104:119]
    buffer_load_dwordx4 v14, s[12:15], s53 offen offset:2048 lds
    ds_read_b128 v[52:55], v18 offset:0
    ds_read_b64_tr_b16 v[68:69], v22 offset:0
    ds_read_b64_tr_b16 v[70:71], v22 offset:768
    v_mfma_f32_32x32x16_bf16 v[120:135], v[80:83], v[48:51], v[120:135]
    ds_read_b128 v[56:59], v18 offset:4096
    s_add_u32 m0, s58, 82048
    ds_read_b64_tr_b16 v[72:73], v22 offset:32
    ds_read_b64_tr_b16 v[74:75], v22 offset:800
    ds_read_b64_tr_b16 v[76:77], v22 offset:64
    v_mfma_f32_16x16x32_bf16 v[92:95], v[32:35], v[80:83], v[92:95]
    buffer_load_dwordx4 v12, s[16:19], s53 offen lds
    v_mfma_f32_32x32x16_bf16 v[136:151], v[84:87], v[44:47], v[136:151]
    ds_read_b64_tr_b16 v[78:79], v22 offset:832
    v_fmac_f32 v27, v28, v28
    v_fmac_f32 v27, v29, v29
    v_lshlrev_b32 v30, 16, v41
    v_and_b32 v31, 0xffff0000, v41
    v_mfma_f32_16x16x32_bf16 v[244:247], v[32:35], v[40:43], v[244:247]
    buffer_load_dwordx4 v13, s[16:19], s53 offen offset:1024 lds
    v_mfma_f32_32x32x16_bf16 v[152:167], v[84:87], v[48:51], v[152:167]
    v_fmac_f32 v27, v30, v30
    v_fmac_f32 v27, v31, v31
    v_lshlrev_b32 v28, 16, v42
    v_and_b32 v29, 0xffff0000, v42
    v_fmac_f32 v27, v28, v28
    v_mfma_f32_16x16x32_bf16 v[96:99], v[32:35], v[84:87], v[96:99]
    s_waitcnt lgkmcnt(8)
    v_mfma_f32_32x32x16_bf16 v[168:183], v[88:91], v[44:47], v[168:183]
    buffer_load_dwordx4 v14, s[16:19], s53 offen offset:2048 lds
    v_fmac_f32 v27, v29, v29
    v_lshlrev_b32 v30, 16, v43
    v_and_b32 v31, 0xffff0000, v43
    v_mfma_f32_32x32x16_bf16 v[184:199], v[88:91], v[48:51], v[184:199]
    v_fmac_f32 v27, v30, v30
    v_fmac_f32 v27, v31, v31
    v_mfma_f32_16x16x32_bf16 v[100:103], v[32:35], v[88:91], v[100:103]
    s_waitcnt lgkmcnt(2)
    v_mfma_f32_32x32x16_bf16 v[104:119], v[68:71], v[52:55], v[104:119]
    ds_read_b128 v[60:63], v19 offset:0
    ds_read_b64_tr_b16 v[80:81], v23 offset:0
    ds_read_b64_tr_b16 v[82:83], v23 offset:768
    ds_read_b128 v[64:67], v19 offset:4096
    ds_read_b64_tr_b16 v[84:85], v23 offset:32
    v_mfma_f32_32x32x16_bf16 v[120:135], v[68:71], v[56:59], v[120:135]
    ds_read_b64_tr_b16 v[86:87], v23 offset:800
    ds_read_b64_tr_b16 v[88:89], v23 offset:64
    ds_read_b64_tr_b16 v[90:91], v23 offset:832
    v_lshlrev_b32 v28, 16, v52
    v_and_b32 v29, 0xffff0000, v52
    v_mfma_f32_32x32x16_bf16 v[136:151], v[72:75], v[52:55], v[136:151]
    v_fmac_f32 v26, v28, v28
    v_fmac_f32 v26, v29, v29
    v_lshlrev_b32 v30, 16, v53
    v_and_b32 v31, 0xffff0000, v53
    v_fmac_f32 v26, v30, v30
    v_mfma_f32_32x32x16_bf16 v[152:167], v[72:75], v[56:59], v[152:167]
    v_fmac_f32 v26, v31, v31
    v_lshlrev_b32 v28, 16, v54
    v_and_b32 v29, 0xffff0000, v54
    v_fmac_f32 v26, v28, v28
    v_fmac_f32 v26, v29, v29
    v_mfma_f32_16x16x32_bf16 v[240:243], v[32:35], v[52:55], v[240:243]
    s_waitcnt lgkmcnt(8)
    v_mfma_f32_32x32x16_bf16 v[168:183], v[76:79], v[52:55], v[168:183]
    v_lshlrev_b32 v30, 16, v55
    v_and_b32 v31, 0xffff0000, v55
    v_fmac_f32 v26, v30, v30
    v_fmac_f32 v26, v31, v31
    v_lshlrev_b32 v28, 16, v56
    v_mfma_f32_32x32x16_bf16 v[184:199], v[76:79], v[56:59], v[184:199]
    v_and_b32 v29, 0xffff0000, v56
    v_fmac_f32 v27, v28, v28
    v_fmac_f32 v27, v29, v29
    v_lshlrev_b32 v30, 16, v57
    s_waitcnt lgkmcnt(2)
    v_mfma_f32_32x32x16_bf16 v[104:119], v[80:83], v[60:63], v[104:119]
    v_and_b32 v31, 0xffff0000, v57
    v_fmac_f32 v27, v30, v30
    v_fmac_f32 v27, v31, v31
    s_waitcnt vmcnt(10) lgkmcnt(0)
    s_barrier
    v_mfma_f32_32x32x16_bf16 v[120:135], v[80:83], v[64:67], v[120:135]
    ds_read_b128 v[36:39], v16 offset:41024
    ds_read_b64_tr_b16 v[68:69], v20 offset:41024
    ds_read_b64_tr_b16 v[70:71], v20 offset:41792
    s_add_u32 m0, s56, 0
    ds_read_b128 v[40:43], v16 offset:45120
    v_mfma_f32_32x32x16_bf16 v[136:151], v[84:87], v[60:63], v[136:151]
    buffer_load_dwordx4 v8, s[8:11], s46 offen lds
    ds_read_b64_tr_b16 v[72:73], v20 offset:41056
    ds_read_b64_tr_b16 v[74:75], v20 offset:41824
    ds_read_b64_tr_b16 v[76:77], v20 offset:41088
    v_mfma_f32_32x32x16_bf16 v[152:167], v[84:87], v[64:67], v[152:167]
    buffer_load_dwordx4 v9, s[8:11], s46 offen offset:1024 lds
    ds_read_b64_tr_b16 v[78:79], v20 offset:41856
    v_lshlrev_b32 v28, 16, v58
    v_and_b32 v29, 0xffff0000, v58
    v_mfma_f32_16x16x32_bf16 v[244:247], v[32:35], v[56:59], v[244:247]
    v_fmac_f32 v27, v28, v28
    v_mfma_f32_32x32x16_bf16 v[168:183], v[88:91], v[60:63], v[168:183]
    v_fmac_f32 v27, v29, v29
    v_lshlrev_b32 v30, 16, v59
    v_and_b32 v31, 0xffff0000, v59
    v_fmac_f32 v27, v30, v30
    v_fmac_f32 v27, v31, v31
    v_mfma_f32_32x32x16_bf16 v[184:199], v[88:91], v[64:67], v[184:199]
    buffer_load_dwordx4 v10, s[8:11], s46 offen offset:2048 lds
    s_waitcnt lgkmcnt(2)
    v_mfma_f32_32x32x16_bf16 v[104:119], v[68:71], v[36:39], v[104:119]
    ds_read_b128 v[44:47], v17 offset:41024
    ds_read_b64_tr_b16 v[80:81], v21 offset:41024
    ds_read_b64_tr_b16 v[82:83], v21 offset:41792
    ds_read_b128 v[48:51], v17 offset:45120
    ds_read_b64_tr_b16 v[84:85], v21 offset:41056
    v_mfma_f32_32x32x16_bf16 v[120:135], v[68:71], v[40:43], v[120:135]
    buffer_load_dwordx4 v11, s[8:11], s46 offen offset:3072 lds
    ds_read_b64_tr_b16 v[86:87], v21 offset:41824
    ds_read_b64_tr_b16 v[88:89], v21 offset:41088
    ds_read_b64_tr_b16 v[90:91], v21 offset:41856
    v_mfma_f32_16x16x32_bf16 v[92:95], v[32:35], v[68:71], v[92:95]
    v_lshlrev_b32 v28, 16, v36
    v_mfma_f32_32x32x16_bf16 v[136:151], v[72:75], v[36:39], v[136:151]
    s_add_u32 m0, s57, 0
    v_and_b32 v29, 0xffff0000, v36
    v_fmac_f32 v26, v28, v28
    v_fmac_f32 v26, v29, v29
    v_lshlrev_b32 v30, 16, v37
    v_mfma_f32_16x16x32_bf16 v[240:243], v[32:35], v[36:39], v[240:243]
    buffer_load_dwordx4 v12, s[12:15], s54 offen lds
    v_mfma_f32_32x32x16_bf16 v[152:167], v[72:75], v[40:43], v[152:167]
    v_and_b32 v31, 0xffff0000, v37
    v_fmac_f32 v26, v30, v30
    v_fmac_f32 v26, v31, v31
    v_lshlrev_b32 v28, 16, v38
    v_and_b32 v29, 0xffff0000, v38
    v_mfma_f32_16x16x32_bf16 v[96:99], v[32:35], v[72:75], v[96:99]
    s_waitcnt lgkmcnt(8)
    v_mfma_f32_32x32x16_bf16 v[168:183], v[76:79], v[36:39], v[168:183]
    buffer_load_dwordx4 v13, s[12:15], s54 offen offset:1024 lds
    v_fmac_f32 v26, v28, v28
    v_fmac_f32 v26, v29, v29
    v_lshlrev_b32 v30, 16, v39
    v_mfma_f32_32x32x16_bf16 v[184:199], v[76:79], v[40:43], v[184:199]
    v_and_b32 v31, 0xffff0000, v39
    v_fmac_f32 v26, v30, v30
    v_fmac_f32 v26, v31, v31
    v_lshlrev_b32 v28, 16, v40
    v_and_b32 v29, 0xffff0000, v40
    v_mfma_f32_16x16x32_bf16 v[100:103], v[32:35], v[76:79], v[100:103]
    s_waitcnt lgkmcnt(2)
    v_mfma_f32_32x32x16_bf16 v[104:119], v[80:83], v[44:47], v[104:119]
    buffer_load_dwordx4 v14, s[12:15], s54 offen offset:2048 lds
    ds_read_b128 v[52:55], v18 offset:41024
    ds_read_b64_tr_b16 v[68:69], v22 offset:41024
    ds_read_b64_tr_b16 v[70:71], v22 offset:41792
    v_mfma_f32_32x32x16_bf16 v[120:135], v[80:83], v[48:51], v[120:135]
    ds_read_b128 v[56:59], v18 offset:45120
    s_add_u32 m0, s58, 0
    ds_read_b64_tr_b16 v[72:73], v22 offset:41056
    ds_read_b64_tr_b16 v[74:75], v22 offset:41824
    ds_read_b64_tr_b16 v[76:77], v22 offset:41088
    v_mfma_f32_16x16x32_bf16 v[92:95], v[32:35], v[80:83], v[92:95]
    buffer_load_dwordx4 v12, s[16:19], s54 offen lds
    v_mfma_f32_32x32x16_bf16 v[136:151], v[84:87], v[44:47], v[136:151]
    ds_read_b64_tr_b16 v[78:79], v22 offset:41856
    v_fmac_f32 v27, v28, v28
    v_fmac_f32 v27, v29, v29
    v_lshlrev_b32 v30, 16, v41
    v_and_b32 v31, 0xffff0000, v41
    v_mfma_f32_16x16x32_bf16 v[244:247], v[32:35], v[40:43], v[244:247]
    buffer_load_dwordx4 v13, s[16:19], s54 offen offset:1024 lds
    v_mfma_f32_32x32x16_bf16 v[152:167], v[84:87], v[48:51], v[152:167]
    v_fmac_f32 v27, v30, v30
    v_fmac_f32 v27, v31, v31
    v_lshlrev_b32 v28, 16, v42
    v_and_b32 v29, 0xffff0000, v42
    v_fmac_f32 v27, v28, v28
    v_mfma_f32_16x16x32_bf16 v[96:99], v[32:35], v[84:87], v[96:99]
    s_waitcnt lgkmcnt(8)
    v_mfma_f32_32x32x16_bf16 v[168:183], v[88:91], v[44:47], v[168:183]
    buffer_load_dwordx4 v14, s[16:19], s54 offen offset:2048 lds
    v_fmac_f32 v27, v29, v29
    v_lshlrev_b32 v30, 16, v43
    v_and_b32 v31, 0xffff0000, v43
    v_mfma_f32_32x32x16_bf16 v[184:199], v[88:91], v[48:51], v[184:199]
    v_fmac_f32 v27, v30, v30
    v_fmac_f32 v27, v31, v31
    v_mfma_f32_16x16x32_bf16 v[100:103], v[32:35], v[88:91], v[100:103]
    s_waitcnt lgkmcnt(2)
    v_mfma_f32_32x32x16_bf16 v[104:119], v[68:71], v[52:55], v[104:119]
    ds_read_b128 v[60:63], v19 offset:41024
    ds_read_b64_tr_b16 v[80:81], v23 offset:41024
    ds_read_b64_tr_b16 v[82:83], v23 offset:41792
    ds_read_b128 v[64:67], v19 offset:45120
    ds_read_b64_tr_b16 v[84:85], v23 offset:41056
    v_mfma_f32_32x32x16_bf16 v[120:135], v[68:71], v[56:59], v[120:135]
    ds_read_b64_tr_b16 v[86:87], v23 offset:41824
    ds_read_b64_tr_b16 v[88:89], v23 offset:41088
    ds_read_b64_tr_b16 v[90:91], v23 offset:41856
    v_lshlrev_b32 v28, 16, v52
    v_and_b32 v29, 0xffff0000, v52
    v_mfma_f32_32x32x16_bf16 v[136:151], v[72:75], v[52:55], v[136:151]
    v_fmac_f32 v26, v28, v28
    v_fmac_f32 v26, v29, v29
    v_lshlrev_b32 v30, 16, v53
    v_and_b32 v31, 0xffff0000, v53
    v_fmac_f32 v26, v30, v30
    v_mfma_f32_32x32x16_bf16 v[152:167], v[72:75], v[56:59], v[152:167]
    v_fmac_f32 v26, v31, v31
    v_lshlrev_b32 v28, 16, v54
    v_and_b32 v29, 0xffff0000, v54
    v_fmac_f32 v26, v28, v28
    v_fmac_f32 v26, v29, v29
    v_mfma_f32_16x16x32_bf16 v[240:243], v[32:35], v[52:55], v[240:243]
    s_waitcnt lgkmcnt(8)
    v_mfma_f32_32x32x16_bf16 v[168:183], v[76:79], v[52:55], v[168:183]
    v_lshlrev_b32 v30, 16, v55
    v_and_b32 v31, 0xffff0000, v55
    v_fmac_f32 v26, v30, v30
    v_fmac_f32 v26, v31, v31
    v_lshlrev_b32 v28, 16, v56
    v_mfma_f32_32x32x16_bf16 v[184:199], v[76:79], v[56:59], v[184:199]
    v_and_b32 v29, 0xffff0000, v56
    v_fmac_f32 v27, v28, v28
    v_fmac_f32 v27, v29, v29
    v_lshlrev_b32 v30, 16, v57
    s_waitcnt lgkmcnt(2)
    v_mfma_f32_32x32x16_bf16 v[104:119], v[80:83], v[60:63], v[104:119]
    v_and_b32 v31, 0xffff0000, v57
    v_fmac_f32 v27, v30, v30
    v_fmac_f32 v27, v31, v31
    s_waitcnt vmcnt(10) lgkmcnt(0)
    s_barrier
    v_mfma_f32_32x32x16_bf16 v[120:135], v[80:83], v[64:67], v[120:135]
    ds_read_b128 v[36:39], v248 offset:0
    ds_read_b64_tr_b16 v[68:69], v252 offset:0
    ds_read_b64_tr_b16 v[70:71], v252 offset:768
    s_add_u32 m0, s56, 41024
    ds_read_b128 v[40:43], v248 offset:4096
    v_mfma_f32_32x32x16_bf16 v[136:151], v[84:87], v[60:63], v[136:151]
    buffer_load_dwordx4 v8, s[8:11], s47 offen lds
    ds_read_b64_tr_b16 v[72:73], v252 offset:32
    ds_read_b64_tr_b16 v[74:75], v252 offset:800
    ds_read_b64_tr_b16 v[76:77], v252 offset:64
    v_mfma_f32_32x32x16_bf16 v[152:167], v[84:87], v[64:67], v[152:167]
    buffer_load_dwordx4 v9, s[8:11], s47 offen offset:1024 lds
    ds_read_b64_tr_b16 v[78:79], v252 offset:832
    v_lshlrev_b32 v28, 16, v58
    v_and_b32 v29, 0xffff0000, v58
    v_mfma_f32_16x16x32_bf16 v[244:247], v[32:35], v[56:59], v[244:247]
    v_fmac_f32 v27, v28, v28
    v_mfma_f32_32x32x16_bf16 v[168:183], v[88:91], v[60:63], v[168:183]
    v_fmac_f32 v27, v29, v29
    v_lshlrev_b32 v30, 16, v59
    v_and_b32 v31, 0xffff0000, v59
    v_fmac_f32 v27, v30, v30
    v_fmac_f32 v27, v31, v31
    v_mfma_f32_32x32x16_bf16 v[184:199], v[88:91], v[64:67], v[184:199]
    buffer_load_dwordx4 v10, s[8:11], s47 offen offset:2048 lds
    s_waitcnt lgkmcnt(2)
    v_mfma_f32_32x32x16_bf16 v[104:119], v[68:71], v[36:39], v[104:119]
    ds_read_b128 v[44:47], v249 offset:0
    ds_read_b64_tr_b16 v[80:81], v253 offset:0
    ds_read_b64_tr_b16 v[82:83], v253 offset:768
    ds_read_b128 v[48:51], v249 offset:4096
    ds_read_b64_tr_b16 v[84:85], v253 offset:32
    v_mfma_f32_32x32x16_bf16 v[120:135], v[68:71], v[40:43], v[120:135]
    buffer_load_dwordx4 v11, s[8:11], s47 offen offset:3072 lds
    ds_read_b64_tr_b16 v[86:87], v253 offset:800
    ds_read_b64_tr_b16 v[88:89], v253 offset:64
    ds_read_b64_tr_b16 v[90:91], v253 offset:832
    v_mfma_f32_16x16x32_bf16 v[92:95], v[32:35], v[68:71], v[92:95]
    v_lshlrev_b32 v28, 16, v36
    v_mfma_f32_32x32x16_bf16 v[136:151], v[72:75], v[36:39], v[136:151]
    s_add_u32 m0, s57, 41024
    v_and_b32 v29, 0xffff0000, v36
    v_fmac_f32 v26, v28, v28
    v_fmac_f32 v26, v29, v29
    v_lshlrev_b32 v30, 16, v37
    v_mfma_f32_16x16x32_bf16 v[240:243], v[32:35], v[36:39], v[240:243]
    buffer_load_dwordx4 v12, s[12:15], s55 offen lds
    v_mfma_f32_32x32x16_bf16 v[152:167], v[72:75], v[40:43], v[152:167]
    v_and_b32 v31, 0xffff0000, v37
    v_fmac_f32 v26, v30, v30
    v_fmac_f32 v26, v31, v31
    v_lshlrev_b32 v28, 16, v38
    v_and_b32 v29, 0xffff0000, v38
    v_mfma_f32_16x16x32_bf16 v[96:99], v[32:35], v[72:75], v[96:99]
    s_waitcnt lgkmcnt(8)
    v_mfma_f32_32x32x16_bf16 v[168:183], v[76:79], v[36:39], v[168:183]
    buffer_load_dwordx4 v13, s[12:15], s55 offen offset:1024 lds
    v_fmac_f32 v26, v28, v28
    v_fmac_f32 v26, v29, v29
    v_lshlrev_b32 v30, 16, v39
    v_mfma_f32_32x32x16_bf16 v[184:199], v[76:79], v[40:43], v[184:199]
    v_and_b32 v31, 0xffff0000, v39
    v_fmac_f32 v26, v30, v30
    v_fmac_f32 v26, v31, v31
    v_lshlrev_b32 v28, 16, v40
    v_and_b32 v29, 0xffff0000, v40
    v_mfma_f32_16x16x32_bf16 v[100:103], v[32:35], v[76:79], v[100:103]
    s_waitcnt lgkmcnt(2)
    v_mfma_f32_32x32x16_bf16 v[104:119], v[80:83], v[44:47], v[104:119]
    buffer_load_dwordx4 v14, s[12:15], s55 offen offset:2048 lds
    ds_read_b128 v[52:55], v250 offset:0
    ds_read_b64_tr_b16 v[68:69], v254 offset:0
    ds_read_b64_tr_b16 v[70:71], v254 offset:768
    v_mfma_f32_32x32x16_bf16 v[120:135], v[80:83], v[48:51], v[120:135]
    ds_read_b128 v[56:59], v250 offset:4096
    s_add_u32 m0, s58, 41024
    ds_read_b64_tr_b16 v[72:73], v254 offset:32
    ds_read_b64_tr_b16 v[74:75], v254 offset:800
    ds_read_b64_tr_b16 v[76:77], v254 offset:64
    v_mfma_f32_16x16x32_bf16 v[92:95], v[32:35], v[80:83], v[92:95]
    buffer_load_dwordx4 v12, s[16:19], s55 offen lds
    v_mfma_f32_32x32x16_bf16 v[136:151], v[84:87], v[44:47], v[136:151]
    ds_read_b64_tr_b16 v[78:79], v254 offset:832
    v_fmac_f32 v27, v28, v28
    v_fmac_f32 v27, v29, v29
    v_lshlrev_b32 v30, 16, v41
    v_and_b32 v31, 0xffff0000, v41
    v_mfma_f32_16x16x32_bf16 v[244:247], v[32:35], v[40:43], v[244:247]
    buffer_load_dwordx4 v13, s[16:19], s55 offen offset:1024 lds
    v_mfma_f32_32x32x16_bf16 v[152:167], v[84:87], v[48:51], v[152:167]
    v_fmac_f32 v27, v30, v30
    v_fmac_f32 v27, v31, v31
    v_lshlrev_b32 v28, 16, v42
    v_and_b32 v29, 0xffff0000, v42
    v_fmac_f32 v27, v28, v28
    v_mfma_f32_16x16x32_bf16 v[96:99], v[32:35], v[84:87], v[96:99]
    s_waitcnt lgkmcnt(8)
    v_mfma_f32_32x32x16_bf16 v[168:183], v[88:91], v[44:47], v[168:183]
    buffer_load_dwordx4 v14, s[16:19], s55 offen offset:2048 lds
    v_fmac_f32 v27, v29, v29
    v_lshlrev_b32 v30, 16, v43
    v_and_b32 v31, 0xffff0000, v43
    v_mfma_f32_32x32x16_bf16 v[184:199], v[88:91], v[48:51], v[184:199]
    v_fmac_f32 v27, v30, v30
    v_fmac_f32 v27, v31, v31
    v_mfma_f32_16x16x32_bf16 v[100:103], v[32:35], v[88:91], v[100:103]
    s_waitcnt lgkmcnt(2)
    v_mfma_f32_32x32x16_bf16 v[104:119], v[68:71], v[52:55], v[104:119]
    buffer_load_dword a254, v7, s[4:7], s3 offen
    ds_read_b128 v[60:63], v251 offset:0
    ds_read_b64_tr_b16 v[80:81], v255 offset:0
    ds_read_b64_tr_b16 v[82:83], v255 offset:768
    v_mfma_f32_32x32x16_bf16 v[120:135], v[68:71], v[56:59], v[120:135]
    ds_read_b128 v[64:67], v251 offset:4096
    ds_read_b64_tr_b16 v[84:85], v255 offset:32
    ds_read_b64_tr_b16 v[86:87], v255 offset:800
    ds_read_b64_tr_b16 v[88:89], v255 offset:64
    ds_read_b64_tr_b16 v[90:91], v255 offset:832
    v_mfma_f32_32x32x16_bf16 v[136:151], v[72:75], v[52:55], v[136:151]
    buffer_load_dword a254, v7, s[4:7], s3 offen offset:128
    v_lshlrev_b32 v28, 16, v52
    v_and_b32 v29, 0xffff0000, v52
    v_fmac_f32 v26, v28, v28
    v_mfma_f32_32x32x16_bf16 v[152:167], v[72:75], v[56:59], v[152:167]
    v_fmac_f32 v26, v29, v29
    v_lshlrev_b32 v30, 16, v53
    v_and_b32 v31, 0xffff0000, v53
    v_fmac_f32 v26, v30, v30
    v_fmac_f32 v26, v31, v31
    v_mfma_f32_16x16x32_bf16 v[240:243], v[32:35], v[52:55], v[240:243]
    s_waitcnt lgkmcnt(8)
    v_mfma_f32_32x32x16_bf16 v[168:183], v[76:79], v[52:55], v[168:183]
    s_add_u32 s3, s3, 22528
    buffer_load_dword a254, v7, s[4:7], s3 offen
    v_lshlrev_b32 v28, 16, v54
    v_and_b32 v29, 0xffff0000, v54
    v_mfma_f32_32x32x16_bf16 v[184:199], v[76:79], v[56:59], v[184:199]
    buffer_load_dword a254, v7, s[4:7], s3 offen offset:128
    v_fmac_f32 v26, v28, v28
    v_fmac_f32 v26, v29, v29
    s_waitcnt lgkmcnt(2)
    v_mfma_f32_32x32x16_bf16 v[104:119], v[80:83], v[60:63], v[104:119]
    v_lshlrev_b32 v30, 16, v55
    v_and_b32 v31, 0xffff0000, v55
    v_fmac_f32 v26, v30, v30
    s_waitcnt vmcnt(14) lgkmcnt(0)
    s_barrier
    v_mfma_f32_32x32x16_bf16 v[120:135], v[80:83], v[64:67], v[120:135]
    ds_read_b128 v[36:39], v16 offset:0
    ds_read_b64_tr_b16 v[68:69], v20 offset:0
    ds_read_b64_tr_b16 v[70:71], v20 offset:768
    ds_read_b128 v[40:43], v16 offset:4096
    ds_read_b64_tr_b16 v[72:73], v20 offset:32
    v_mfma_f32_32x32x16_bf16 v[136:151], v[84:87], v[60:63], v[136:151]
    ds_read_b64_tr_b16 v[74:75], v20 offset:800
    ds_read_b64_tr_b16 v[76:77], v20 offset:64
    ds_read_b64_tr_b16 v[78:79], v20 offset:832
    v_fmac_f32 v26, v31, v31
    v_lshlrev_b32 v28, 16, v56
    v_mfma_f32_32x32x16_bf16 v[152:167], v[84:87], v[64:67], v[152:167]
    v_and_b32 v29, 0xffff0000, v56
    v_fmac_f32 v27, v28, v28
    v_fmac_f32 v27, v29, v29
    v_lshlrev_b32 v30, 16, v57
    v_and_b32 v31, 0xffff0000, v57
    v_mfma_f32_16x16x32_bf16 v[244:247], v[32:35], v[56:59], v[244:247]
    v_fmac_f32 v27, v30, v30
    v_mfma_f32_32x32x16_bf16 v[168:183], v[88:91], v[60:63], v[168:183]
    v_fmac_f32 v27, v31, v31
    v_lshlrev_b32 v28, 16, v58
    v_and_b32 v29, 0xffff0000, v58
    v_fmac_f32 v27, v28, v28
    v_fmac_f32 v27, v29, v29
    v_mfma_f32_32x32x16_bf16 v[184:199], v[88:91], v[64:67], v[184:199]
    v_lshlrev_b32 v30, 16, v59
    v_and_b32 v31, 0xffff0000, v59
    v_fmac_f32 v27, v30, v30
    v_fmac_f32 v27, v31, v31
    s_waitcnt lgkmcnt(2)
    v_mfma_f32_32x32x16_bf16 v[104:119], v[68:71], v[36:39], v[104:119]
    ds_read_b128 v[44:47], v17 offset:0
    ds_read_b64_tr_b16 v[80:81], v21 offset:0
    ds_read_b64_tr_b16 v[82:83], v21 offset:768
    ds_read_b128 v[48:51], v17 offset:4096
    ds_read_b64_tr_b16 v[84:85], v21 offset:32
    v_mfma_f32_32x32x16_bf16 v[120:135], v[68:71], v[40:43], v[120:135]
    ds_read_b64_tr_b16 v[86:87], v21 offset:800
    ds_read_b64_tr_b16 v[88:89], v21 offset:64
    ds_read_b64_tr_b16 v[90:91], v21 offset:832
    v_lshlrev_b32 v28, 16, v36
    v_and_b32 v29, 0xffff0000, v36
    v_mfma_f32_16x16x32_bf16 v[92:95], v[32:35], v[68:71], v[92:95]
    v_fmac_f32 v26, v28, v28
    v_mfma_f32_32x32x16_bf16 v[136:151], v[72:75], v[36:39], v[136:151]
    v_fmac_f32 v26, v29, v29
    v_lshlrev_b32 v30, 16, v37
    v_and_b32 v31, 0xffff0000, v37
    v_fmac_f32 v26, v30, v30
    v_fmac_f32 v26, v31, v31
    v_mfma_f32_16x16x32_bf16 v[240:243], v[32:35], v[36:39], v[240:243]
    v_lshlrev_b32 v28, 16, v38
    v_mfma_f32_32x32x16_bf16 v[152:167], v[72:75], v[40:43], v[152:167]
    v_and_b32 v29, 0xffff0000, v38
    v_fmac_f32 v26, v28, v28
    v_fmac_f32 v26, v29, v29
    v_lshlrev_b32 v30, 16, v39
    v_and_b32 v31, 0xffff0000, v39
    v_mfma_f32_16x16x32_bf16 v[96:99], v[32:35], v[72:75], v[96:99]
    s_waitcnt lgkmcnt(8)
    v_mfma_f32_32x32x16_bf16 v[168:183], v[76:79], v[36:39], v[168:183]
    v_fmac_f32 v26, v30, v30
    v_fmac_f32 v26, v31, v31
    v_lshlrev_b32 v28, 16, v40
    v_and_b32 v29, 0xffff0000, v40
    v_fmac_f32 v27, v28, v28
    v_mfma_f32_32x32x16_bf16 v[184:199], v[76:79], v[40:43], v[184:199]
    v_fmac_f32 v27, v29, v29
    v_lshlrev_b32 v30, 16, v41
    v_and_b32 v31, 0xffff0000, v41
    v_fmac_f32 v27, v30, v30
    v_fmac_f32 v27, v31, v31
    v_mfma_f32_16x16x32_bf16 v[100:103], v[32:35], v[76:79], v[100:103]
    s_waitcnt lgkmcnt(2)
    v_mfma_f32_32x32x16_bf16 v[104:119], v[80:83], v[44:47], v[104:119]
    ds_read_b128 v[52:55], v18 offset:0
    ds_read_b64_tr_b16 v[68:69], v22 offset:0
    ds_read_b64_tr_b16 v[70:71], v22 offset:768
    ds_read_b128 v[56:59], v18 offset:4096
    ds_read_b64_tr_b16 v[72:73], v22 offset:32
    v_mfma_f32_32x32x16_bf16 v[120:135], v[80:83], v[48:51], v[120:135]
    ds_read_b64_tr_b16 v[74:75], v22 offset:800
    ds_read_b64_tr_b16 v[76:77], v22 offset:64
    ds_read_b64_tr_b16 v[78:79], v22 offset:832
    v_lshlrev_b32 v28, 16, v42
    v_and_b32 v29, 0xffff0000, v42
    v_mfma_f32_16x16x32_bf16 v[92:95], v[32:35], v[80:83], v[92:95]
    v_fmac_f32 v27, v28, v28
    v_mfma_f32_32x32x16_bf16 v[136:151], v[84:87], v[44:47], v[136:151]
    v_fmac_f32 v27, v29, v29
    v_lshlrev_b32 v30, 16, v43
    v_and_b32 v31, 0xffff0000, v43
    v_fmac_f32 v27, v30, v30
    v_fmac_f32 v27, v31, v31
    v_mfma_f32_16x16x32_bf16 v[244:247], v[32:35], v[40:43], v[244:247]
    v_mfma_f32_32x32x16_bf16 v[152:167], v[84:87], v[48:51], v[152:167]
    v_mfma_f32_16x16x32_bf16 v[96:99], v[32:35], v[84:87], v[96:99]
    s_waitcnt lgkmcnt(8)
    v_mfma_f32_32x32x16_bf16 v[168:183], v[88:91], v[44:47], v[168:183]
    v_mfma_f32_32x32x16_bf16 v[184:199], v[88:91], v[48:51], v[184:199]
    v_mfma_f32_16x16x32_bf16 v[100:103], v[32:35], v[88:91], v[100:103]
    s_waitcnt lgkmcnt(2)
    v_mfma_f32_32x32x16_bf16 v[104:119], v[68:71], v[52:55], v[104:119]
    ds_read_b128 v[60:63], v19 offset:0
    ds_read_b64_tr_b16 v[80:81], v23 offset:0
    ds_read_b64_tr_b16 v[82:83], v23 offset:768
    ds_read_b128 v[64:67], v19 offset:4096
    ds_read_b64_tr_b16 v[84:85], v23 offset:32
    v_mfma_f32_32x32x16_bf16 v[120:135], v[68:71], v[56:59], v[120:135]
    ds_read_b64_tr_b16 v[86:87], v23 offset:800
    ds_read_b64_tr_b16 v[88:89], v23 offset:64
    ds_read_b64_tr_b16 v[90:91], v23 offset:832
    v_lshlrev_b32 v28, 16, v52
    v_and_b32 v29, 0xffff0000, v52
    v_mfma_f32_32x32x16_bf16 v[136:151], v[72:75], v[52:55], v[136:151]
    v_fmac_f32 v26, v28, v28
    v_fmac_f32 v26, v29, v29
    v_lshlrev_b32 v30, 16, v53
    v_and_b32 v31, 0xffff0000, v53
    v_fmac_f32 v26, v30, v30
    v_mfma_f32_32x32x16_bf16 v[152:167], v[72:75], v[56:59], v[152:167]
    v_fmac_f32 v26, v31, v31
    v_lshlrev_b32 v28, 16, v54
    v_and_b32 v29, 0xffff0000, v54
    v_fmac_f32 v26, v28, v28
    v_fmac_f32 v26, v29, v29
    v_mfma_f32_16x16x32_bf16 v[240:243], v[32:35], v[52:55], v[240:243]
    s_waitcnt lgkmcnt(8)
    v_mfma_f32_32x32x16_bf16 v[168:183], v[76:79], v[52:55], v[168:183]
    v_lshlrev_b32 v30, 16, v55
    v_and_b32 v31, 0xffff0000, v55
    v_fmac_f32 v26, v30, v30
    v_fmac_f32 v26, v31, v31
    v_lshlrev_b32 v28, 16, v56
    v_mfma_f32_32x32x16_bf16 v[184:199], v[76:79], v[56:59], v[184:199]
    v_and_b32 v29, 0xffff0000, v56
    v_fmac_f32 v27, v28, v28
    v_fmac_f32 v27, v29, v29
    v_lshlrev_b32 v30, 16, v57
    s_waitcnt lgkmcnt(2)
    v_mfma_f32_32x32x16_bf16 v[104:119], v[80:83], v[60:63], v[104:119]
    v_and_b32 v31, 0xffff0000, v57
    v_fmac_f32 v27, v30, v30
    v_fmac_f32 v27, v31, v31
    s_waitcnt vmcnt(4) lgkmcnt(0)
    s_barrier
    v_mfma_f32_32x32x16_bf16 v[120:135], v[80:83], v[64:67], v[120:135]
    ds_read_b128 v[36:39], v16 offset:41024
    ds_read_b64_tr_b16 v[68:69], v20 offset:41024
    ds_read_b64_tr_b16 v[70:71], v20 offset:41792
    ds_read_b128 v[40:43], v16 offset:45120
    ds_read_b64_tr_b16 v[72:73], v20 offset:41056
    v_mfma_f32_32x32x16_bf16 v[136:151], v[84:87], v[60:63], v[136:151]
    ds_read_b64_tr_b16 v[74:75], v20 offset:41824
    ds_read_b64_tr_b16 v[76:77], v20 offset:41088
    ds_read_b64_tr_b16 v[78:79], v20 offset:41856
    v_lshlrev_b32 v28, 16, v58
    v_and_b32 v29, 0xffff0000, v58
    v_mfma_f32_32x32x16_bf16 v[152:167], v[84:87], v[64:67], v[152:167]
    v_fmac_f32 v27, v28, v28
    v_fmac_f32 v27, v29, v29
    v_lshlrev_b32 v30, 16, v59
    v_and_b32 v31, 0xffff0000, v59
    v_fmac_f32 v27, v30, v30
    v_mfma_f32_16x16x32_bf16 v[244:247], v[32:35], v[56:59], v[244:247]
    v_fmac_f32 v27, v31, v31
    v_mfma_f32_32x32x16_bf16 v[168:183], v[88:91], v[60:63], v[168:183]
    v_and_b32 v12, 7, v1
    v_lshrrev_b32 v13, 2, v1
    v_and_b32 v13, 4, v13
    v_xor_b32 v12, v12, v13
    v_lshlrev_b32 v12, 4, v12
    v_mfma_f32_32x32x16_bf16 v[184:199], v[88:91], v[64:67], v[184:199]
    v_lshrrev_b32 v13, 3, v1
    v_lshl_add_u32 v8, v13, 10, v12
    v_add_u32 v9, 7168, v8
    v_add_u32 v10, 14336, v8
    s_waitcnt lgkmcnt(2)
    v_mfma_f32_32x32x16_bf16 v[104:119], v[68:71], v[36:39], v[104:119]
    ds_read_b128 v[44:47], v17 offset:41024
    ds_read_b64_tr_b16 v[80:81], v21 offset:41024
    ds_read_b64_tr_b16 v[82:83], v21 offset:41792
    ds_read_b128 v[48:51], v17 offset:45120
    ds_read_b64_tr_b16 v[84:85], v21 offset:41056
    v_mfma_f32_32x32x16_bf16 v[120:135], v[68:71], v[40:43], v[120:135]
    ds_read_b64_tr_b16 v[86:87], v21 offset:41824
    ds_read_b64_tr_b16 v[88:89], v21 offset:41088
    ds_read_b64_tr_b16 v[90:91], v21 offset:41856
    v_lshlrev_b32 v28, 16, v36
    v_and_b32 v29, 0xffff0000, v36
    v_mfma_f32_16x16x32_bf16 v[92:95], v[32:35], v[68:71], v[92:95]
    v_fmac_f32 v26, v28, v28
    v_mfma_f32_32x32x16_bf16 v[136:151], v[72:75], v[36:39], v[136:151]
    v_fmac_f32 v26, v29, v29
    v_lshlrev_b32 v30, 16, v37
    v_and_b32 v31, 0xffff0000, v37
    v_fmac_f32 v26, v30, v30
    v_fmac_f32 v26, v31, v31
    v_mfma_f32_16x16x32_bf16 v[240:243], v[32:35], v[36:39], v[240:243]
    v_lshlrev_b32 v28, 16, v38
    v_mfma_f32_32x32x16_bf16 v[152:167], v[72:75], v[40:43], v[152:167]
    v_and_b32 v29, 0xffff0000, v38
    v_fmac_f32 v26, v28, v28
    v_fmac_f32 v26, v29, v29
    v_lshlrev_b32 v30, 16, v39
    v_and_b32 v31, 0xffff0000, v39
    v_mfma_f32_16x16x32_bf16 v[96:99], v[32:35], v[72:75], v[96:99]
    s_waitcnt lgkmcnt(8)
    v_mfma_f32_32x32x16_bf16 v[168:183], v[76:79], v[36:39], v[168:183]
    v_fmac_f32 v26, v30, v30
    v_fmac_f32 v26, v31, v31
    v_lshlrev_b32 v28, 16, v40
    v_and_b32 v29, 0xffff0000, v40
    v_fmac_f32 v27, v28, v28
    v_mfma_f32_32x32x16_bf16 v[184:199], v[76:79], v[40:43], v[184:199]
    v_fmac_f32 v27, v29, v29
    v_lshlrev_b32 v30, 16, v41
    v_and_b32 v31, 0xffff0000, v41
    v_fmac_f32 v27, v30, v30
    v_fmac_f32 v27, v31, v31
    v_mfma_f32_16x16x32_bf16 v[100:103], v[32:35], v[76:79], v[100:103]
    s_waitcnt lgkmcnt(2)
    v_mfma_f32_32x32x16_bf16 v[104:119], v[80:83], v[44:47], v[104:119]
    ds_read_b128 v[52:55], v18 offset:41024
    ds_read_b64_tr_b16 v[68:69], v22 offset:41024
    ds_read_b64_tr_b16 v[70:71], v22 offset:41792
    ds_read_b128 v[56:59], v18 offset:45120
    ds_read_b64_tr_b16 v[72:73], v22 offset:41056
    v_mfma_f32_32x32x16_bf16 v[120:135], v[80:83], v[48:51], v[120:135]
    ds_read_b64_tr_b16 v[74:75], v22 offset:41824
    ds_read_b64_tr_b16 v[76:77], v22 offset:41088
    ds_read_b64_tr_b16 v[78:79], v22 offset:41856
    v_lshlrev_b32 v28, 16, v42
    v_and_b32 v29, 0xffff0000, v42
    v_mfma_f32_16x16x32_bf16 v[92:95], v[32:35], v[80:83], v[92:95]
    v_fmac_f32 v27, v28, v28
    v_mfma_f32_32x32x16_bf16 v[136:151], v[84:87], v[44:47], v[136:151]
    v_fmac_f32 v27, v29, v29
    v_lshlrev_b32 v30, 16, v43
    v_and_b32 v31, 0xffff0000, v43
    v_fmac_f32 v27, v30, v30
    v_fmac_f32 v27, v31, v31
    v_mfma_f32_16x16x32_bf16 v[244:247], v[32:35], v[40:43], v[244:247]
    v_add_u32 v11, 21504, v8
    v_mfma_f32_32x32x16_bf16 v[152:167], v[84:87], v[48:51], v[152:167]
    v_mfma_f32_16x16x32_bf16 v[96:99], v[32:35], v[84:87], v[96:99]
    s_waitcnt lgkmcnt(8)
    v_mfma_f32_32x32x16_bf16 v[168:183], v[88:91], v[44:47], v[168:183]
    v_mfma_f32_32x32x16_bf16 v[184:199], v[88:91], v[48:51], v[184:199]
    v_mfma_f32_16x16x32_bf16 v[100:103], v[32:35], v[88:91], v[100:103]
    s_waitcnt lgkmcnt(2)
    v_mfma_f32_32x32x16_bf16 v[104:119], v[68:71], v[52:55], v[104:119]
    ds_read_b128 v[60:63], v19 offset:41024
    ds_read_b64_tr_b16 v[80:81], v23 offset:41024
    ds_read_b64_tr_b16 v[82:83], v23 offset:41792
    ds_read_b128 v[64:67], v19 offset:45120
    ds_read_b64_tr_b16 v[84:85], v23 offset:41056
    v_mfma_f32_32x32x16_bf16 v[120:135], v[68:71], v[56:59], v[120:135]
    ds_read_b64_tr_b16 v[86:87], v23 offset:41824
    ds_read_b64_tr_b16 v[88:89], v23 offset:41088
    ds_read_b64_tr_b16 v[90:91], v23 offset:41856
    v_lshlrev_b32 v28, 16, v52
    v_and_b32 v29, 0xffff0000, v52
    v_mfma_f32_32x32x16_bf16 v[136:151], v[72:75], v[52:55], v[136:151]
    v_fmac_f32 v26, v28, v28
    v_fmac_f32 v26, v29, v29
    v_lshlrev_b32 v30, 16, v53
    v_and_b32 v31, 0xffff0000, v53
    v_fmac_f32 v26, v30, v30
    v_mfma_f32_32x32x16_bf16 v[152:167], v[72:75], v[56:59], v[152:167]
    v_fmac_f32 v26, v31, v31
    v_lshlrev_b32 v28, 16, v54
    v_and_b32 v29, 0xffff0000, v54
    v_fmac_f32 v26, v28, v28
    v_fmac_f32 v26, v29, v29
    v_mfma_f32_16x16x32_bf16 v[240:243], v[32:35], v[52:55], v[240:243]
    s_waitcnt lgkmcnt(8)
    v_mfma_f32_32x32x16_bf16 v[168:183], v[76:79], v[52:55], v[168:183]
    v_lshlrev_b32 v30, 16, v55
    v_and_b32 v31, 0xffff0000, v55
    v_fmac_f32 v26, v30, v30
    v_fmac_f32 v26, v31, v31
    v_lshlrev_b32 v28, 16, v56
    v_mfma_f32_32x32x16_bf16 v[184:199], v[76:79], v[56:59], v[184:199]
    v_and_b32 v29, 0xffff0000, v56
    v_fmac_f32 v27, v28, v28
    v_fmac_f32 v27, v29, v29
    v_lshlrev_b32 v30, 16, v57
    s_waitcnt lgkmcnt(2)
    v_mfma_f32_32x32x16_bf16 v[104:119], v[80:83], v[60:63], v[104:119]
    v_and_b32 v31, 0xffff0000, v57
    v_fmac_f32 v27, v30, v30
    v_fmac_f32 v27, v31, v31
    v_lshlrev_b32 v28, 16, v58
    v_and_b32 v29, 0xffff0000, v58
    v_mfma_f32_32x32x16_bf16 v[120:135], v[80:83], v[64:67], v[120:135]
    v_fmac_f32 v27, v28, v28
    v_fmac_f32 v27, v29, v29
    v_lshlrev_b32 v30, 16, v59
    v_and_b32 v31, 0xffff0000, v59
    v_fmac_f32 v27, v30, v30
    v_mfma_f32_32x32x16_bf16 v[136:151], v[84:87], v[60:63], v[136:151]
    v_fmac_f32 v27, v31, v31
    v_mfma_f32_32x32x16_bf16 v[152:167], v[84:87], v[64:67], v[152:167]
    v_mfma_f32_16x16x32_bf16 v[244:247], v[32:35], v[56:59], v[244:247]
    s_waitcnt lgkmcnt(0)
    v_mfma_f32_32x32x16_bf16 v[168:183], v[88:91], v[60:63], v[168:183]
    v_mfma_f32_32x32x16_bf16 v[184:199], v[88:91], v[64:67], v[184:199]
    v_mov_b32 v93, v96
    v_mov_b32 v94, v100
    v_mov_b32 v24, v240
    s_nop 4
    v_mov_b32 v25, v244
    ds_write_b128 v3, v[24:27]
    ds_write_b128 v3, v[92:95] offset:1024
    v_mov_b32 v45, 0
    v_mov_b32 v46, 0
    v_mov_b32 v47, 0
    v_mov_b32 v49, 0
    v_mov_b32 v50, 0
    v_mov_b32 v51, 0
    s_waitcnt lgkmcnt(0)
    s_barrier
    ds_read_b128 v[36:39], v4
    ds_read_b128 v[40:43], v5 offset:1024
    s_xor_b32 s97, s94, 0
    s_add_u32 m0, s93, 0
    s_lshl_b32 s96, s97, 16
    s_add_u32 s96, s96, s92
    buffer_load_dwordx4 v8, s[4:7], s96 offen lds
    s_waitcnt lgkmcnt(1)
    v_pk_add_f32 v[24:25], v[24:25], v[36:37]
    v_pk_add_f32 v[26:27], v[26:27], v[38:39]
    v_mov_b32 v28, v24
    v_mov_b32 v30, v25
    v_mov_b32 v29, v26
    v_mov_b32 v31, v27
    s_nop 0
    v_permlane32_swap_b32 v24, v28
    v_permlane32_swap_b32 v25, v30
    v_permlane32_swap_b32 v26, v29
    v_permlane32_swap_b32 v27, v31
    v_add_f32 v24, v24, v28
    v_add_f32 v25, v25, v30
    v_add_f32 v26, v26, v29
    v_add_f32 v27, v27, v31
    v_mul_f32 v24, 0xbb000000, v24
    v_mul_f32 v25, 0xbb000000, v25
    v_mul_f32 v26, 0x3b000000, v26
    v_mul_f32 v27, 0x3b000000, v27
    v_cvt_pk_bf16_f32 v44, v24, v24
    v_cvt_pk_bf16_f32 v48, v25, v25
    buffer_load_dwordx4 v9, s[4:7], s96 offen offset:1024 lds
    v_fma_f32 v26, -v24, v24, v26
    v_fma_f32 v27, -v25, v25, v27
    v_max_f32 v26, 0, v26
    v_max_f32 v27, 0, v27
    v_cvt_pk_bf16_f32 v26, v26, v26
    v_cvt_pk_bf16_f32 v27, v27, v27
    v_and_b32 v26, 0xffff0000, v26
    v_and_b32 v27, 0xffff0000, v27
    v_add_f32 v26, 0x3727c5ac, v26
    v_add_f32 v27, 0x3727c5ac, v27
    v_cvt_pk_bf16_f32 v26, v26, v26
    v_cvt_pk_bf16_f32 v27, v27, v27
    v_and_b32 v26, 0xffff0000, v26
    v_and_b32 v27, 0xffff0000, v27
    v_sqrt_f32 v26, v26
    v_sqrt_f32 v27, v27
    v_cvt_pk_bf16_f32 v26, v26, v26
    v_cvt_pk_bf16_f32 v27, v27, v27
    buffer_load_dwordx4 v10, s[4:7], s96 offen offset:2048 lds
    v_and_b32 v26, 0xffff0000, v26
    v_and_b32 v27, 0xffff0000, v27
    v_rcp_f32 v206, v26
    v_rcp_f32 v214, v27
    v_mul_f32 v204, v26, v26
    v_mul_f32 v212, v27, v27
    v_mul_f32 v200, 0xc0135761, v206
    v_mul_f32 v208, 0xc0135761, v214
    v_mul_f32 v28, v206, v206
    v_mul_f32 v30, v214, v214
    v_mul_f32 v28, 0x3d372713, v28
    v_mul_f32 v30, 0x3d372713, v30
    v_mul_f32 v202, v200, v28
    v_mul_f32 v210, v208, v30
    v_mov_b32 v201, v200
    v_mov_b32 v209, v208
    v_mov_b32 v203, v202
    v_mov_b32 v211, v210
    v_mov_b32 v205, v204
    v_mov_b32 v213, v212
    s_waitcnt lgkmcnt(0)
    v_add_f32 v92, v92, v40
    v_add_f32 v93, v93, v41
    v_add_f32 v94, v94, v42
    v_cvt_pk_bf16_f32 v28, v92, v92
    v_and_b32 v28, 0xffff0000, v28
    v_sub_f32 v28, v92, v28
    v_cvt_pk_bf16_f32 v68, v92, v28
    v_cvt_pk_bf16_f32 v28, v93, v93
    v_and_b32 v28, 0xffff0000, v28
    v_sub_f32 v28, v93, v28
    v_cvt_pk_bf16_f32 v72, v93, v28
    v_cvt_pk_bf16_f32 v28, v94, v94
    v_and_b32 v28, 0xffff0000, v28
    v_sub_f32 v28, v94, v28
    v_cvt_pk_bf16_f32 v76, v94, v28
    s_nop 1
    v_mfma_f32_32x32x16_bf16 v[104:119], v[68:71], v[44:47], v[104:119]
    v_mfma_f32_32x32x16_bf16 v[120:135], v[68:71], v[48:51], v[120:135]
    v_mfma_f32_32x32x16_bf16 v[136:151], v[72:75], v[44:47], v[136:151]
    v_mfma_f32_32x32x16_bf16 v[152:167], v[72:75], v[48:51], v[152:167]
    v_mfma_f32_32x32x16_bf16 v[168:183], v[76:79], v[44:47], v[168:183]
    v_mfma_f32_32x32x16_bf16 v[184:199], v[76:79], v[48:51], v[184:199]
    buffer_load_dwordx4 v11, s[4:7], s96 offen offset:3072 lds
    s_nop 6
    v_pk_mul_f32 v[52:53], v[104:105], v[104:105]
    v_pk_mul_f32 v[54:55], v[106:107], v[106:107]
    v_pk_mul_f32 v[56:57], v[108:109], v[108:109]
    v_pk_mul_f32 v[58:59], v[110:111], v[110:111]
    v_pk_fma_f32 v[52:53], v[52:53], v[202:203], v[200:201]
    v_pk_fma_f32 v[54:55], v[54:55], v[202:203], v[200:201]
    v_pk_fma_f32 v[56:57], v[56:57], v[202:203], v[200:201]
    v_pk_fma_f32 v[58:59], v[58:59], v[202:203], v[200:201]
    v_pk_mul_f32 v[52:53], v[52:53], v[104:105]
    v_pk_mul_f32 v[54:55], v[54:55], v[106:107]
    v_pk_mul_f32 v[56:57], v[56:57], v[108:109]
    v_pk_mul_f32 v[58:59], v[58:59], v[110:111]
    s_xor_b32 s97, s94, 1
    s_add_u32 m0, s93, 16384
    s_lshl_b32 s96, s97, 16
    s_add_u32 s96, s96, s92
    buffer_load_dwordx4 v8, s[4:7], s96 offen lds
    v_exp_f32 v52, v52
    v_exp_f32 v53, v53
    v_exp_f32 v54, v54
    v_exp_f32 v55, v55
    v_exp_f32 v56, v56
    v_exp_f32 v57, v57
    v_exp_f32 v58, v58
    v_exp_f32 v59, v59
    v_pk_mul_f32 v[104:105], v[104:105], v[112:113]
    v_pk_mul_f32 v[106:107], v[106:107], v[114:115]
    v_pk_mul_f32 v[108:109], v[108:109], v[116:117]
    v_pk_mul_f32 v[110:111], v[110:111], v[118:119]
    buffer_load_dwordx4 v9, s[4:7], s96 offen offset:1024 lds
    v_pk_fma_f32 v[52:53], v[52:53], v[204:205], v[204:205]
    v_pk_fma_f32 v[54:55], v[54:55], v[204:205], v[204:205]
    v_pk_fma_f32 v[56:57], v[56:57], v[204:205], v[204:205]
    v_pk_fma_f32 v[58:59], v[58:59], v[204:205], v[204:205]
    v_rcp_f32 v52, v52
    v_rcp_f32 v53, v53
    v_rcp_f32 v54, v54
    v_rcp_f32 v55, v55
    v_rcp_f32 v56, v56
    v_rcp_f32 v57, v57
    v_rcp_f32 v58, v58
    v_rcp_f32 v59, v59
    buffer_load_dwordx4 v10, s[4:7], s96 offen offset:2048 lds
    s_nop 0
    v_pk_mul_f32 v[104:105], v[104:105], v[52:53]
    v_pk_mul_f32 v[106:107], v[106:107], v[54:55]
    v_pk_mul_f32 v[108:109], v[108:109], v[56:57]
    v_pk_mul_f32 v[110:111], v[110:111], v[58:59]
    v_cvt_pk_bf16_f32 v216, v104, v105
    v_cvt_pk_bf16_f32 v217, v106, v107
    v_cvt_pk_bf16_f32 v218, v108, v109
    v_cvt_pk_bf16_f32 v219, v110, v111
    buffer_store_dwordx4 v[216:219], v2, s[20:23], s59 offen offset:0 sc1
    v_pk_mul_f32 v[60:61], v[120:121], v[120:121]
    v_pk_mul_f32 v[62:63], v[122:123], v[122:123]
    v_pk_mul_f32 v[64:65], v[124:125], v[124:125]
    v_pk_mul_f32 v[66:67], v[126:127], v[126:127]
    v_pk_fma_f32 v[60:61], v[60:61], v[210:211], v[208:209]
    v_pk_fma_f32 v[62:63], v[62:63], v[210:211], v[208:209]
    v_pk_fma_f32 v[64:65], v[64:65], v[210:211], v[208:209]
    v_pk_fma_f32 v[66:67], v[66:67], v[210:211], v[208:209]
    v_pk_mul_f32 v[60:61], v[60:61], v[120:121]
    v_pk_mul_f32 v[62:63], v[62:63], v[122:123]
    v_pk_mul_f32 v[64:65], v[64:65], v[124:125]
    v_pk_mul_f32 v[66:67], v[66:67], v[126:127]
    buffer_load_dwordx4 v11, s[4:7], s96 offen offset:3072 lds
    v_exp_f32 v60, v60
    v_exp_f32 v61, v61
    v_exp_f32 v62, v62
    v_exp_f32 v63, v63
    v_exp_f32 v64, v64
    v_exp_f32 v65, v65
    v_exp_f32 v66, v66
    v_exp_f32 v67, v67
    v_pk_mul_f32 v[120:121], v[120:121], v[128:129]
    v_pk_mul_f32 v[122:123], v[122:123], v[130:131]
    v_pk_mul_f32 v[124:125], v[124:125], v[132:133]
    v_pk_mul_f32 v[126:127], v[126:127], v[134:135]
    s_xor_b32 s97, s94, 2
    s_add_u32 m0, s93, 32768
    s_lshl_b32 s96, s97, 16
    s_add_u32 s96, s96, s92
    buffer_load_dwordx4 v8, s[4:7], s96 offen lds
    v_pk_fma_f32 v[60:61], v[60:61], v[212:213], v[212:213]
    v_pk_fma_f32 v[62:63], v[62:63], v[212:213], v[212:213]
    v_pk_fma_f32 v[64:65], v[64:65], v[212:213], v[212:213]
    v_pk_fma_f32 v[66:67], v[66:67], v[212:213], v[212:213]
    v_rcp_f32 v60, v60
    v_rcp_f32 v61, v61
    v_rcp_f32 v62, v62
    v_rcp_f32 v63, v63
    v_rcp_f32 v64, v64
    v_rcp_f32 v65, v65
    v_rcp_f32 v66, v66
    v_rcp_f32 v67, v67
    buffer_load_dwordx4 v9, s[4:7], s96 offen offset:1024 lds
    s_nop 0
    v_pk_mul_f32 v[120:121], v[120:121], v[60:61]
    v_pk_mul_f32 v[122:123], v[122:123], v[62:63]
    v_pk_mul_f32 v[124:125], v[124:125], v[64:65]
    v_pk_mul_f32 v[126:127], v[126:127], v[66:67]
    v_cvt_pk_bf16_f32 v220, v120, v121
    v_cvt_pk_bf16_f32 v221, v122, v123
    v_cvt_pk_bf16_f32 v222, v124, v125
    v_cvt_pk_bf16_f32 v223, v126, v127
    buffer_store_dwordx4 v[220:223], v2, s[20:23], s60 offen offset:0 sc1
    v_pk_mul_f32 v[52:53], v[136:137], v[136:137]
    v_pk_mul_f32 v[54:55], v[138:139], v[138:139]
    v_pk_mul_f32 v[56:57], v[140:141], v[140:141]
    v_pk_mul_f32 v[58:59], v[142:143], v[142:143]
    v_pk_fma_f32 v[52:53], v[52:53], v[202:203], v[200:201]
    v_pk_fma_f32 v[54:55], v[54:55], v[202:203], v[200:201]
    v_pk_fma_f32 v[56:57], v[56:57], v[202:203], v[200:201]
    v_pk_fma_f32 v[58:59], v[58:59], v[202:203], v[200:201]
    v_pk_mul_f32 v[52:53], v[52:53], v[136:137]
    v_pk_mul_f32 v[54:55], v[54:55], v[138:139]
    v_pk_mul_f32 v[56:57], v[56:57], v[140:141]
    v_pk_mul_f32 v[58:59], v[58:59], v[142:143]
    buffer_load_dwordx4 v10, s[4:7], s96 offen offset:2048 lds
    v_exp_f32 v52, v52
    v_exp_f32 v53, v53
    v_exp_f32 v54, v54
    v_exp_f32 v55, v55
    v_exp_f32 v56, v56
    v_exp_f32 v57, v57
    v_exp_f32 v58, v58
    v_exp_f32 v59, v59
    v_pk_mul_f32 v[136:137], v[136:137], v[144:145]
    v_pk_mul_f32 v[138:139], v[138:139], v[146:147]
    v_pk_mul_f32 v[140:141], v[140:141], v[148:149]
    v_pk_mul_f32 v[142:143], v[142:143], v[150:151]
    buffer_load_dwordx4 v11, s[4:7], s96 offen offset:3072 lds
    v_pk_fma_f32 v[52:53], v[52:53], v[204:205], v[204:205]
    v_pk_fma_f32 v[54:55], v[54:55], v[204:205], v[204:205]
    v_pk_fma_f32 v[56:57], v[56:57], v[204:205], v[204:205]
    v_pk_fma_f32 v[58:59], v[58:59], v[204:205], v[204:205]
    v_rcp_f32 v52, v52
    v_rcp_f32 v53, v53
    v_rcp_f32 v54, v54
    v_rcp_f32 v55, v55
    v_rcp_f32 v56, v56
    v_rcp_f32 v57, v57
    v_rcp_f32 v58, v58
    v_rcp_f32 v59, v59
    s_xor_b32 s97, s94, 3
    s_add_u32 m0, s93, 49152
    s_lshl_b32 s96, s97, 16
    s_add_u32 s96, s96, s92
    buffer_load_dwordx4 v8, s[4:7], s96 offen lds
    s_nop 0
    v_pk_mul_f32 v[136:137], v[136:137], v[52:53]
    v_pk_mul_f32 v[138:139], v[138:139], v[54:55]
    v_pk_mul_f32 v[140:141], v[140:141], v[56:57]
    v_pk_mul_f32 v[142:143], v[142:143], v[58:59]
    v_cvt_pk_bf16_f32 v224, v136, v137
    v_cvt_pk_bf16_f32 v225, v138, v139
    v_cvt_pk_bf16_f32 v226, v140, v141
    v_cvt_pk_bf16_f32 v227, v142, v143
    buffer_store_dwordx4 v[224:227], v2, s[20:23], s59 offen offset:1024 sc1
    v_pk_mul_f32 v[60:61], v[152:153], v[152:153]
    v_pk_mul_f32 v[62:63], v[154:155], v[154:155]
    v_pk_mul_f32 v[64:65], v[156:157], v[156:157]
    v_pk_mul_f32 v[66:67], v[158:159], v[158:159]
    v_pk_fma_f32 v[60:61], v[60:61], v[210:211], v[208:209]
    v_pk_fma_f32 v[62:63], v[62:63], v[210:211], v[208:209]
    v_pk_fma_f32 v[64:65], v[64:65], v[210:211], v[208:209]
    v_pk_fma_f32 v[66:67], v[66:67], v[210:211], v[208:209]
    v_pk_mul_f32 v[60:61], v[60:61], v[152:153]
    v_pk_mul_f32 v[62:63], v[62:63], v[154:155]
    v_pk_mul_f32 v[64:65], v[64:65], v[156:157]
    v_pk_mul_f32 v[66:67], v[66:67], v[158:159]
    buffer_load_dwordx4 v9, s[4:7], s96 offen offset:1024 lds
    v_exp_f32 v60, v60
    v_exp_f32 v61, v61
    v_exp_f32 v62, v62
    v_exp_f32 v63, v63
    v_exp_f32 v64, v64
    v_exp_f32 v65, v65
    v_exp_f32 v66, v66
    v_exp_f32 v67, v67
    v_pk_mul_f32 v[152:153], v[152:153], v[160:161]
    v_pk_mul_f32 v[154:155], v[154:155], v[162:163]
    v_pk_mul_f32 v[156:157], v[156:157], v[164:165]
    v_pk_mul_f32 v[158:159], v[158:159], v[166:167]
    buffer_load_dwordx4 v10, s[4:7], s96 offen offset:2048 lds
    v_pk_fma_f32 v[60:61], v[60:61], v[212:213], v[212:213]
    v_pk_fma_f32 v[62:63], v[62:63], v[212:213], v[212:213]
    v_pk_fma_f32 v[64:65], v[64:65], v[212:213], v[212:213]
    v_pk_fma_f32 v[66:67], v[66:67], v[212:213], v[212:213]
    v_rcp_f32 v60, v60
    v_rcp_f32 v61, v61
    v_rcp_f32 v62, v62
    v_rcp_f32 v63, v63
    v_rcp_f32 v64, v64
    v_rcp_f32 v65, v65
    v_rcp_f32 v66, v66
    v_rcp_f32 v67, v67
    buffer_load_dwordx4 v11, s[4:7], s96 offen offset:3072 lds
    s_nop 0
    v_pk_mul_f32 v[152:153], v[152:153], v[60:61]
    v_pk_mul_f32 v[154:155], v[154:155], v[62:63]
    v_pk_mul_f32 v[156:157], v[156:157], v[64:65]
    v_pk_mul_f32 v[158:159], v[158:159], v[66:67]
    v_cvt_pk_bf16_f32 v228, v152, v153
    v_cvt_pk_bf16_f32 v229, v154, v155
    v_cvt_pk_bf16_f32 v230, v156, v157
    v_cvt_pk_bf16_f32 v231, v158, v159
    buffer_store_dwordx4 v[228:231], v2, s[20:23], s60 offen offset:1024 sc1
    v_pk_mul_f32 v[52:53], v[168:169], v[168:169]
    v_pk_mul_f32 v[54:55], v[170:171], v[170:171]
    v_pk_mul_f32 v[56:57], v[172:173], v[172:173]
    v_pk_mul_f32 v[58:59], v[174:175], v[174:175]
    v_pk_fma_f32 v[52:53], v[52:53], v[202:203], v[200:201]
    v_pk_fma_f32 v[54:55], v[54:55], v[202:203], v[200:201]
    v_pk_fma_f32 v[56:57], v[56:57], v[202:203], v[200:201]
    v_pk_fma_f32 v[58:59], v[58:59], v[202:203], v[200:201]
    v_pk_mul_f32 v[52:53], v[52:53], v[168:169]
    v_pk_mul_f32 v[54:55], v[54:55], v[170:171]
    v_pk_mul_f32 v[56:57], v[56:57], v[172:173]
    v_pk_mul_f32 v[58:59], v[58:59], v[174:175]
    v_exp_f32 v52, v52
    v_exp_f32 v53, v53
    v_exp_f32 v54, v54
    v_exp_f32 v55, v55
    v_exp_f32 v56, v56
    v_exp_f32 v57, v57
    v_exp_f32 v58, v58
    v_exp_f32 v59, v59
    v_pk_mul_f32 v[168:169], v[168:169], v[176:177]
    v_pk_mul_f32 v[170:171], v[170:171], v[178:179]
    v_pk_mul_f32 v[172:173], v[172:173], v[180:181]
    v_pk_mul_f32 v[174:175], v[174:175], v[182:183]
    v_pk_fma_f32 v[52:53], v[52:53], v[204:205], v[204:205]
    v_pk_fma_f32 v[54:55], v[54:55], v[204:205], v[204:205]
    v_pk_fma_f32 v[56:57], v[56:57], v[204:205], v[204:205]
    v_pk_fma_f32 v[58:59], v[58:59], v[204:205], v[204:205]
    v_rcp_f32 v52, v52
    v_rcp_f32 v53, v53
    v_rcp_f32 v54, v54
    v_rcp_f32 v55, v55
    v_rcp_f32 v56, v56
    v_rcp_f32 v57, v57
    v_rcp_f32 v58, v58
    v_rcp_f32 v59, v59
    s_nop 0
    v_pk_mul_f32 v[168:169], v[168:169], v[52:53]
    v_pk_mul_f32 v[170:171], v[170:171], v[54:55]
    v_pk_mul_f32 v[172:173], v[172:173], v[56:57]
    v_pk_mul_f32 v[174:175], v[174:175], v[58:59]
    v_cvt_pk_bf16_f32 v232, v168, v169
    v_cvt_pk_bf16_f32 v233, v170, v171
    v_cvt_pk_bf16_f32 v234, v172, v173
    v_cvt_pk_bf16_f32 v235, v174, v175
    buffer_store_dwordx4 v[232:235], v2, s[20:23], s59 offen offset:2048 sc1
    v_pk_mul_f32 v[60:61], v[184:185], v[184:185]
    v_pk_mul_f32 v[62:63], v[186:187], v[186:187]
    v_pk_mul_f32 v[64:65], v[188:189], v[188:189]
    v_pk_mul_f32 v[66:67], v[190:191], v[190:191]
    v_pk_fma_f32 v[60:61], v[60:61], v[210:211], v[208:209]
    v_pk_fma_f32 v[62:63], v[62:63], v[210:211], v[208:209]
    v_pk_fma_f32 v[64:65], v[64:65], v[210:211], v[208:209]
    v_pk_fma_f32 v[66:67], v[66:67], v[210:211], v[208:209]
    v_pk_mul_f32 v[60:61], v[60:61], v[184:185]
    v_pk_mul_f32 v[62:63], v[62:63], v[186:187]
    v_pk_mul_f32 v[64:65], v[64:65], v[188:189]
    v_pk_mul_f32 v[66:67], v[66:67], v[190:191]
    v_exp_f32 v60, v60
    v_exp_f32 v61, v61
    v_exp_f32 v62, v62
    v_exp_f32 v63, v63
    v_exp_f32 v64, v64
    v_exp_f32 v65, v65
    v_exp_f32 v66, v66
    v_exp_f32 v67, v67
    v_pk_mul_f32 v[184:185], v[184:185], v[192:193]
    v_pk_mul_f32 v[186:187], v[186:187], v[194:195]
    v_pk_mul_f32 v[188:189], v[188:189], v[196:197]
    v_pk_mul_f32 v[190:191], v[190:191], v[198:199]
    v_pk_fma_f32 v[60:61], v[60:61], v[212:213], v[212:213]
    v_pk_fma_f32 v[62:63], v[62:63], v[212:213], v[212:213]
    v_pk_fma_f32 v[64:65], v[64:65], v[212:213], v[212:213]
    v_pk_fma_f32 v[66:67], v[66:67], v[212:213], v[212:213]
    v_rcp_f32 v60, v60
    v_rcp_f32 v61, v61
    v_rcp_f32 v62, v62
    v_rcp_f32 v63, v63
    v_rcp_f32 v64, v64
    v_rcp_f32 v65, v65
    v_rcp_f32 v66, v66
    v_rcp_f32 v67, v67
    s_nop 0
    v_pk_mul_f32 v[184:185], v[184:185], v[60:61]
    v_pk_mul_f32 v[186:187], v[186:187], v[62:63]
    v_pk_mul_f32 v[188:189], v[188:189], v[64:65]
    v_pk_mul_f32 v[190:191], v[190:191], v[66:67]
    v_cvt_pk_bf16_f32 v236, v184, v185
    v_cvt_pk_bf16_f32 v237, v186, v187
    v_cvt_pk_bf16_f32 v238, v188, v189
    v_cvt_pk_bf16_f32 v239, v190, v191
    buffer_store_dwordx4 v[236:239], v2, s[20:23], s60 offen offset:2048 sc1
    s_mov_b32 s16, s20
    s_mov_b32 s17, s21
    s_mov_b32 s18, 5636096
    s_mov_b32 s19, 0x20000
    s_and_b32 s40, s32, 1
    s_lshr_b32 s41, s32, 1
    v_lshlrev_b32 v6, 4, v1
    s_lshl_b32 s42, s40, 5
    s_add_u32 s42, s42, s99
    s_mul_i32 s43, s42, 88064
    s_mul_i32 s36, s41, 45056
    s_add_u32 s43, s43, s36
    v_and_b32 v2, 31, v1
    v_lshrrev_b32 v3, 5, v1
    s_lshl_b32 s36, s100, 1
    s_add_u32 s36, s36, s41
    s_lshl_b32 s36, s36, 5
    v_add_u32 v4, s36, v2
    s_cmp_ge_u32 s100, 4
    s_cselect_b32 s45, -1.0, 1.0
    s_cselect_b32 s48, -1, 0
    s_cselect_b32 s49, 513, 0
    v_xor_b32 v4, s48, v4
    v_add_u32 v4, s49, v4
    v_and_b32 v5, 1, v4
    v_lshlrev_b32 v14, 15, v5
    v_bfe_u32 v5, v4, 6, 2
    v_lshl_add_u32 v14, v5, 13, v14
    v_bfe_u32 v5, v4, 1, 5
    v_lshl_add_u32 v14, v5, 4, v14
    v_lshl_add_u32 v14, v3, 9, v14
    s_xor_b32 s36, s99, s48
    s_add_u32 s36, s36, s49
    s_and_b32 s36, s36, 31
    s_lshl_b32 s46, s36, 16
    s_add_u32 s46, s46, 6291456
    s_lshl_b32 s36, s41, 12
    s_add_u32 s46, s46, s36
    v_lshlrev_b32 v27, 16, v2
    v_lshl_add_u32 v27, v3, 4, v27
    s_lshl_b32 s47, s42, 10
    s_lshl_b32 s36, s41, 6
    s_add_u32 s47, s47, s36
    s_lshl_b32 s36, s100, 7
    s_add_u32 s47, s47, s36
    v_lshl_add_u32 v26, v2, 6, s42
    v_bfe_u32 v4, v1, 1, 3
    v_lshlrev_b32 v4, 4, v4
    v_lshl_add_u32 v4, v2, 7, v4
    v_lshl_add_u32 v4, v3, 3, v4
    s_lshl_b32 s36, s41, 6
    v_xor_b32 v4, s36, v4
    s_lshl_b32 s36, s40, 12
    s_add_u32 s36, s36, 147456
    v_add_u32 v15, s36, v4
    v_bfe_u32 v4, v1, 2, 2
    v_lshlrev_b32 v12, 7, v4
    v_lshl_add_u32 v12, v3, 9, v12
    v_and_b32 v4, 3, v1
    v_lshl_add_u32 v12, v4, 3, v12
    v_bfe_u32 v4, v1, 4, 1
    v_lshl_add_u32 v12, v4, 5, v12
    v_bfe_u32 v4, v1, 3, 1
    v_lshl_add_u32 v12, v4, 6, v12
    s_mul_i32 s36, s41, 8256
    v_xor_b32 v12, s36, v12
    v_xor_b32 v13, 64, v12
    v_add_u32 v20, 65536, v12
    v_add_u32 v21, 65536, v13
    s_xor_b32 s97, s94, 4
    s_add_u32 m0, s93, 65536
    s_lshl_b32 s96, s97, 16
    s_add_u32 s96, s96, s92
    buffer_load_dwordx4 v8, s[4:7], s96 offen lds
    buffer_load_dwordx4 v9, s[4:7], s96 offen offset:1024 lds
    buffer_load_dwordx4 v10, s[4:7], s96 offen offset:2048 lds
    buffer_load_dwordx4 v11, s[4:7], s96 offen offset:3072 lds
    s_xor_b32 s97, s94, 5
    s_add_u32 m0, s93, 81920
    s_lshl_b32 s96, s97, 16
    s_add_u32 s96, s96, s92
    buffer_load_dwordx4 v8, s[4:7], s96 offen lds
    buffer_load_dwordx4 v9, s[4:7], s96 offen offset:1024 lds
    buffer_load_dwordx4 v10, s[4:7], s96 offen offset:2048 lds
    buffer_load_dwordx4 v11, s[4:7], s96 offen offset:3072 lds
    s_waitcnt vmcnt(8)
    s_barrier
    s_cmp_lg_u32 s32, 0
    s_cbranch_scc1 L_f1
    v_mov_b32 v4, s95
    s_mov_b64 exec, 1
    buffer_store_dword v4, off, s[20:23], s98 sc1
    s_mov_b64 exec, -1
L_f1:
    s_xor_b32 s97, s94, 6
    s_add_u32 m0, s93, 98304
    s_lshl_b32 s96, s97, 16
    s_add_u32 s96, s96, s92
    buffer_load_dwordx4 v8, s[4:7], s96 offen lds
    buffer_load_dwordx4 v9, s[4:7], s96 offen offset:1024 lds
    buffer_load_dwordx4 v10, s[4:7], s96 offen offset:2048 lds
    buffer_load_dwordx4 v11, s[4:7], s96 offen offset:3072 lds
    s_xor_b32 s97, s94, 7
    s_add_u32 m0, s93, 114688
    s_lshl_b32 s96, s97, 16
    s_add_u32 s96, s96, s92
    buffer_load_dwordx4 v8, s[4:7], s96 offen lds
    buffer_load_dwordx4 v9, s[4:7], s96 offen offset:1024 lds
    buffer_load_dwordx4 v10, s[4:7], s96 offen offset:2048 lds
    buffer_load_dwordx4 v11, s[4:7], s96 offen offset:3072 lds
    v_lshrrev_b32 v5, 4, v1
    v_and_b32 v4, 7, v1
    v_xor_b32 v4, v4, v5
    v_lshlrev_b32 v4, 4, v4
    v_lshrrev_b32 v5, 3, v1
    v_lshl_add_u32 v4, v5, 16, v4
    v_xor_b32 v5, 64, v4
    v_add_u32 v5, 523264, v5
    s_lshr_b32 s36, s32, 1
    s_lshl_b32 s36, s36, 5
    s_add_u32 s36, s36, s99
    s_lshl_b32 s36, s36, 10
    s_and_b32 s37, s32, 1
    s_lshl_b32 s37, s37, 20
    s_add_u32 s36, s36, s37
    s_lshl_b32 s37, s100, 7
    s_add_u32 s36, s36, s37
    s_lshl_b32 s37, s32, 11
    s_add_u32 m0, s37, 147456
    s_nop 0
    buffer_load_dwordx4 v4, s[8:11], s36 offen lds
    buffer_load_dwordx4 v5, s[8:11], s36 offen offset:1024 lds
    s_lshl_b32 s36, s41, 5
    v_lshl_add_u32 v4, v3, 2, s36
    v_mul_u32_u24 v4, v4, v26
    v_lshlrev_b32 v5, 2, v26
    s_mov_b32 s52, 0x3a000000
    s_lshl_b32 s36, s32, 12
    s_add_u32 s36, s36, 131072
    v_add_u32 v52, s36, v6
    v_and_b32 v22, 2047, v4
    v_add_u32 v4, v4, v26
    v_cvt_f32_u32 v22, v22
    v_mul_f32 v22, s52, v22
    v_sin_f32 v23, v22
    v_cos_f32 v22, v22
    v_mul_f32 v23, s45, v23
    v_cvt_pk_bf16_f32 v64, v22, v23
    v_and_b32 v24, 2047, v4
    v_add_u32 v4, v4, v26
    v_cvt_f32_u32 v24, v24
    v_mul_f32 v24, s52, v24
    v_sin_f32 v25, v24
    v_cos_f32 v24, v24
    v_mul_f32 v25, s45, v25
    v_cvt_pk_bf16_f32 v65, v24, v25
    v_and_b32 v22, 2047, v4
    v_add_u32 v4, v4, v26
    v_cvt_f32_u32 v22, v22
    v_mul_f32 v22, s52, v22
    v_sin_f32 v23, v22
    v_cos_f32 v22, v22
    v_mul_f32 v23, s45, v23
    v_cvt_pk_bf16_f32 v66, v22, v23
    v_and_b32 v24, 2047, v4
    v_add_u32 v4, v4, v26
    v_cvt_f32_u32 v24, v24
    v_mul_f32 v24, s52, v24
    v_sin_f32 v25, v24
    v_cos_f32 v24, v24
    v_mul_f32 v25, s45, v25
    v_cvt_pk_bf16_f32 v67, v24, v25
    v_add_u32 v4, v4, v5
    ds_write_b128 v52, v[64:67] offset:0
    v_and_b32 v22, 2047, v4
    v_add_u32 v4, v4, v26
    v_cvt_f32_u32 v22, v22
    v_mul_f32 v22, s52, v22
    v_sin_f32 v23, v22
    v_cos_f32 v22, v22
    v_mul_f32 v23, s45, v23
    v_cvt_pk_bf16_f32 v68, v22, v23
    v_and_b32 v24, 2047, v4
    v_add_u32 v4, v4, v26
    v_cvt_f32_u32 v24, v24
    v_mul_f32 v24, s52, v24
    v_sin_f32 v25, v24
    v_cos_f32 v24, v24
    v_mul_f32 v25, s45, v25
    v_cvt_pk_bf16_f32 v69, v24, v25
    v_and_b32 v22, 2047, v4
    v_add_u32 v4, v4, v26
    v_cvt_f32_u32 v22, v22
    v_mul_f32 v22, s52, v22
    v_sin_f32 v23, v22
    v_cos_f32 v22, v22
    v_mul_f32 v23, s45, v23
    v_cvt_pk_bf16_f32 v70, v22, v23
    v_and_b32 v24, 2047, v4
    v_add_u32 v4, v4, v26
    v_cvt_f32_u32 v24, v24
    v_mul_f32 v24, s52, v24
    v_sin_f32 v25, v24
    v_cos_f32 v24, v24
    v_mul_f32 v25, s45, v25
    v_cvt_pk_bf16_f32 v71, v24, v25
    v_add_u32 v4, v4, v5
    ds_write_b128 v52, v[68:71] offset:1024
    v_and_b32 v22, 2047, v4
    v_add_u32 v4, v4, v26
    v_cvt_f32_u32 v22, v22
    v_mul_f32 v22, s52, v22
    v_sin_f32 v23, v22
    v_cos_f32 v22, v22
    v_mul_f32 v23, s45, v23
    v_cvt_pk_bf16_f32 v72, v22, v23
    v_and_b32 v24, 2047, v4
    v_add_u32 v4, v4, v26
    v_cvt_f32_u32 v24, v24
    v_mul_f32 v24, s52, v24
    v_sin_f32 v25, v24
    v_cos_f32 v24, v24
    v_mul_f32 v25, s45, v25
    v_cvt_pk_bf16_f32 v73, v24, v25
    v_and_b32 v22, 2047, v4
    v_add_u32 v4, v4, v26
    v_cvt_f32_u32 v22, v22
    v_mul_f32 v22, s52, v22
    v_sin_f32 v23, v22
    v_cos_f32 v22, v22
    v_mul_f32 v23, s45, v23
    v_cvt_pk_bf16_f32 v74, v22, v23
    v_and_b32 v24, 2047, v4
    v_add_u32 v4, v4, v26
    v_cvt_f32_u32 v24, v24
    v_mul_f32 v24, s52, v24
    v_sin_f32 v25, v24
    v_cos_f32 v24, v24
    v_mul_f32 v25, s45, v25
    v_cvt_pk_bf16_f32 v75, v24, v25
    v_add_u32 v4, v4, v5
    ds_write_b128 v52, v[72:75] offset:2048
    v_and_b32 v22, 2047, v4
    v_add_u32 v4, v4, v26
    v_cvt_f32_u32 v22, v22
    v_mul_f32 v22, s52, v22
    v_sin_f32 v23, v22
    v_cos_f32 v22, v22
    v_mul_f32 v23, s45, v23
    v_cvt_pk_bf16_f32 v76, v22, v23
    v_and_b32 v24, 2047, v4
    v_add_u32 v4, v4, v26
    v_cvt_f32_u32 v24, v24
    v_mul_f32 v24, s52, v24
    v_sin_f32 v25, v24
    v_cos_f32 v24, v24
    v_mul_f32 v25, s45, v25
    v_cvt_pk_bf16_f32 v77, v24, v25
    v_and_b32 v22, 2047, v4
    v_add_u32 v4, v4, v26
    v_cvt_f32_u32 v22, v22
    v_mul_f32 v22, s52, v22
    v_sin_f32 v23, v22
    v_cos_f32 v22, v22
    v_mul_f32 v23, s45, v23
    v_cvt_pk_bf16_f32 v78, v22, v23
    v_and_b32 v24, 2047, v4
    v_add_u32 v4, v4, v26
    v_cvt_f32_u32 v24, v24
    v_mul_f32 v24, s52, v24
    v_sin_f32 v25, v24
    v_cos_f32 v24, v24
    v_mul_f32 v25, s45, v25
    v_cvt_pk_bf16_f32 v79, v24, v25
    v_add_u32 v4, v4, v5
    ds_write_b128 v52, v[76:79] offset:3072
L_join:
    s_load_dwordx2 s[12:13], s[0:1], 72
    ds_read_b64_tr_b16 v[208:209], v12 offset:0
    ds_read_b64_tr_b16 v[210:211], v12 offset:1024
    ds_read_b64_tr_b16 v[212:213], v13 offset:0
    ds_read_b64_tr_b16 v[214:215], v13 offset:1024
    ds_read_b64_tr_b16 v[216:217], v12 offset:2048
    ds_read_b64_tr_b16 v[218:219], v12 offset:3072
    ds_read_b64_tr_b16 v[220:221], v13 offset:2048
    ds_read_b64_tr_b16 v[222:223], v13 offset:3072
    ds_read_b64_tr_b16 v[224:225], v12 offset:4096
    ds_read_b64_tr_b16 v[226:227], v12 offset:5120
    ds_read_b64_tr_b16 v[228:229], v13 offset:4096
    ds_read_b64_tr_b16 v[230:231], v13 offset:5120
    ds_read_b64_tr_b16 v[232:233], v12 offset:6144
    ds_read_b64_tr_b16 v[234:235], v12 offset:7168
    ds_read_b64_tr_b16 v[236:237], v13 offset:6144
    ds_read_b64_tr_b16 v[238:239], v13 offset:7168
    ds_read_b64_tr_b16 v[240:241], v12 offset:16384
    ds_read_b64_tr_b16 v[242:243], v12 offset:17408
    ds_read_b64_tr_b16 v[244:245], v13 offset:16384
    ds_read_b64_tr_b16 v[246:247], v13 offset:17408
    ds_read_b64_tr_b16 v[248:249], v12 offset:18432
    ds_read_b64_tr_b16 v[250:251], v12 offset:19456
    ds_read_b64_tr_b16 v[252:253], v13 offset:18432
    ds_read_b64_tr_b16 v[254:255], v13 offset:19456
    ds_read_b64_tr_b16 a[176:177], v12 offset:20480
    ds_read_b64_tr_b16 a[178:179], v12 offset:21504
    ds_read_b64_tr_b16 a[180:181], v13 offset:20480
    ds_read_b64_tr_b16 a[182:183], v13 offset:21504
    ds_read_b64_tr_b16 a[184:185], v12 offset:22528
    ds_read_b64_tr_b16 a[186:187], v12 offset:23552
    ds_read_b64_tr_b16 a[188:189], v13 offset:22528
    ds_read_b64_tr_b16 a[190:191], v13 offset:23552
    ds_read_b64_tr_b16 a[192:193], v12 offset:32768
    ds_read_b64_tr_b16 a[194:195], v12 offset:33792
    ds_read_b64_tr_b16 a[196:197], v13 offset:32768
    ds_read_b64_tr_b16 a[198:199], v13 offset:33792
    ds_read_b64_tr_b16 a[200:201], v12 offset:34816
    ds_read_b64_tr_b16 a[202:203], v12 offset:35840
    ds_read_b64_tr_b16 a[204:205], v13 offset:34816
    ds_read_b64_tr_b16 a[206:207], v13 offset:35840
    ds_read_b64_tr_b16 a[208:209], v12 offset:36864
    ds_read_b64_tr_b16 a[210:211], v12 offset:37888
    ds_read_b64_tr_b16 a[212:213], v13 offset:36864
    ds_read_b64_tr_b16 a[214:215], v13 offset:37888
    ds_read_b64_tr_b16 a[216:217], v12 offset:38912
    ds_read_b64_tr_b16 a[218:219], v12 offset:39936
    ds_read_b64_tr_b16 a[220:221], v13 offset:38912
    ds_read_b64_tr_b16 a[222:223], v13 offset:39936
    v_xor_b32 v52, 8192, v52
    s_lshl_b32 s36, s32, 12
    s_add_u32 s36, s36, 131072
    v_add_u32 v16, s36, v6
    s_or_b32 s36, s100, s41
    s_cmp_eq_u32 s36, 0
    s_cselect_b32 s50, -1, 0
    s_mov_b32 s51, 0
    s_xor_b32 s52, s46, 4096
    v_lshrrev_b32 v4, 2, v1
    v_and_b32 v5, 1, v4
    v_lshlrev_b32 v5, 3, v5
    s_lshr_b32 s36, s99, 2
    v_add_u32 v5, s36, v5
    s_cmp_eq_u32 s2, 0
    s_cselect_b64 vcc, -1, 0
    v_and_b32 v19, 3, v1
    v_lshlrev_b32 v19, 4, v19
    v_cndmask_b32 v4, v5, v4, vcc
    v_lshl_add_u32 v19, v4, 7, v19
    s_mov_b32 s37, 8912896
    s_waitcnt lgkmcnt(0)
    s_barrier
    buffer_load_dwordx4 v[168:171], v19, s[20:23], s37 offen sc1
    ds_read_b128 v[80:83], v52 offset:0
    ds_read_b128 v[84:87], v52 offset:1024
    ds_read_b128 v[88:91], v52 offset:2048
    ds_read_b128 v[92:95], v52 offset:3072
    s_and_b32 s97, s94, 1
    s_xor_b32 s97, s97, 8
    s_add_u32 m0, s93, 0
    s_lshl_b32 s96, s97, 16
    s_add_u32 s96, s96, s92
    buffer_load_dwordx4 v8, s[4:7], s96 offen lds
    buffer_load_dwordx4 v9, s[4:7], s96 offen offset:1024 lds
    buffer_load_dwordx4 v10, s[4:7], s96 offen offset:2048 lds
    buffer_load_dwordx4 v11, s[4:7], s96 offen offset:3072 lds
    s_and_b32 s97, s94, 1
    s_xor_b32 s97, s97, 9
    s_add_u32 m0, s93, 16384
    s_lshl_b32 s96, s97, 16
    s_add_u32 s96, s96, s92
    buffer_load_dwordx4 v8, s[4:7], s96 offen lds
    buffer_load_dwordx4 v9, s[4:7], s96 offen offset:1024 lds
    buffer_load_dwordx4 v10, s[4:7], s96 offen offset:2048 lds
    buffer_load_dwordx4 v11, s[4:7], s96 offen offset:3072 lds
    s_mov_b32 s97, 10
    s_add_u32 m0, s93, 32768
    s_lshl_b32 s96, s97, 16
    s_add_u32 s96, s96, s92
    buffer_load_dwordx4 v8, s[4:7], s96 offen lds
    buffer_load_dwordx4 v9, s[4:7], s96 offen offset:1024 lds
    buffer_load_dwordx4 v10, s[4:7], s96 offen offset:2048 lds
    buffer_load_dwordx4 v11, s[4:7], s96 offen offset:3072 lds
    s_mov_b32 s14, 2097152
    s_mov_b32 s15, 0x20000
    v_lshlrev_b32 v7, 2, v2
    s_mul_i32 s36, s100, 1536
    s_add_u32 s36, s36, 32768
    v_lshl_add_u32 v22, v1, 7, s36
    v_cmp_gt_u32 vcc, 12, v1
    s_mov_b32 s53, 0
    s_nop 0
    v_cndmask_b32 v22, -1, v22, vcc
    s_waitcnt vmcnt(0) lgkmcnt(0)
    s_cmp_lg_u32 s32, 3
    s_cbranch_scc1 L_synced
L_poll:
    v_cmp_eq_u32 vcc, s95, v168
    v_cmp_eq_u32 s[62:63], s95, v169
    v_cmp_eq_u32 s[64:65], s95, v170
    s_and_b64 vcc, vcc, s[62:63]
    v_cmp_eq_u32 s[62:63], s95, v171
    s_and_b64 vcc, vcc, s[64:65]
    s_and_b64 vcc, vcc, s[62:63]
    s_cmp_eq_u64 vcc, -1
    s_cbranch_scc1 L_polled
    buffer_load_dwordx4 v[168:171], v19, s[20:23], s37 offen sc1
    s_add_u32 s53, s53, 1
    s_waitcnt vmcnt(0)
    s_cmp_lt_u32 s53, 20000
    s_cbranch_scc1 L_poll
L_polled:
    s_cmp_lg_u32 s2, 0
    s_cbranch_scc1 L_synced
    s_mov_b32 s36, 8921088
    v_mov_b32 v4, s95
    s_mov_b64 exec, 1
    buffer_store_dword v4, off, s[20:23], s36 sc1
    s_mov_b64 exec, -1
    s_waitcnt vmcnt(0)
L_synced:
    s_barrier
    s_xor_b32 s54, s94, 0
    s_lshl_b32 s44, s54, 12
    s_add_u32 s44, s44, s43
    buffer_load_dwordx4 a[0:3], v6, s[16:19], s44 offen sc1
    buffer_load_dwordx4 a[4:7], v6, s[16:19], s44 offen offset:1024 sc1
    buffer_load_dwordx4 a[8:11], v6, s[16:19], s44 offen offset:2048 sc1
    buffer_load_dwordx4 a[12:15], v6, s[16:19], s44 offen offset:3072 sc1
    s_xor_b32 s54, s94, 1
    s_lshl_b32 s44, s54, 12
    s_add_u32 s44, s44, s43
    buffer_load_dwordx4 a[16:19], v6, s[16:19], s44 offen sc1
    buffer_load_dwordx4 a[20:23], v6, s[16:19], s44 offen offset:1024 sc1
    buffer_load_dwordx4 a[24:27], v6, s[16:19], s44 offen offset:2048 sc1
    buffer_load_dwordx4 a[28:31], v6, s[16:19], s44 offen offset:3072 sc1
    s_xor_b32 s54, s94, 2
    s_lshl_b32 s44, s54, 12
    s_add_u32 s44, s44, s43
    buffer_load_dwordx4 a[32:35], v6, s[16:19], s44 offen sc1
    buffer_load_dwordx4 a[36:39], v6, s[16:19], s44 offen offset:1024 sc1
    buffer_load_dwordx4 a[40:43], v6, s[16:19], s44 offen offset:2048 sc1
    buffer_load_dwordx4 a[44:47], v6, s[16:19], s44 offen offset:3072 sc1
    s_xor_b32 s54, s94, 3
    s_lshl_b32 s44, s54, 12
    s_add_u32 s44, s44, s43
    buffer_load_dwordx4 a[48:51], v6, s[16:19], s44 offen sc1
    s_waitcnt vmcnt(12)
    v_mfma_f32_32x32x16_bf16 v[48:63], v[212:215], a[0:3], 0
    v_mfma_f32_32x32x16_bf16 v[32:47], v[208:211], a[0:3], 0
    buffer_load_dwordx4 a[52:55], v6, s[16:19], s44 offen offset:1024 sc1
    s_waitcnt vmcnt(12)
    v_mfma_f32_32x32x16_bf16 v[48:63], v[220:223], a[4:7], v[48:63]
    v_mfma_f32_32x32x16_bf16 v[32:47], v[216:219], a[4:7], v[32:47]
    buffer_load_dwordx4 a[56:59], v6, s[16:19], s44 offen offset:2048 sc1
    s_waitcnt vmcnt(12)
    v_mfma_f32_32x32x16_bf16 v[48:63], v[228:231], a[8:11], v[48:63]
    v_mfma_f32_32x32x16_bf16 v[32:47], v[224:227], a[8:11], v[32:47]
    buffer_load_dwordx4 a[60:63], v6, s[16:19], s44 offen offset:3072 sc1
    s_waitcnt vmcnt(12)
    v_mfma_f32_32x32x16_bf16 v[48:63], v[236:239], a[12:15], v[48:63]
    v_mfma_f32_32x32x16_bf16 v[32:47], v[232:235], a[12:15], v[32:47]
    s_xor_b32 s54, s94, 4
    s_lshl_b32 s44, s54, 12
    s_add_u32 s44, s44, s43
    buffer_load_dwordx4 a[64:67], v6, s[16:19], s44 offen sc1
    v_xor_b32 v22, 0, v15
    ds_read_b64 v[160:161], v22
    s_waitcnt vmcnt(12)
    v_mfma_f32_32x32x16_bf16 v[48:63], v[244:247], a[16:19], v[48:63]
    v_mfma_f32_32x32x16_bf16 v[32:47], v[240:243], a[16:19], v[32:47]
    buffer_load_dwordx4 a[68:71], v6, s[16:19], s44 offen offset:1024 sc1
    v_xor_b32 v22, 16, v15
    ds_read_b64 v[162:163], v22
    s_waitcnt vmcnt(12)
    v_mfma_f32_32x32x16_bf16 v[48:63], v[252:255], a[20:23], v[48:63]
    v_mfma_f32_32x32x16_bf16 v[32:47], v[248:251], a[20:23], v[32:47]
    buffer_load_dwordx4 a[72:75], v6, s[16:19], s44 offen offset:2048 sc1
    v_xor_b32 v22, 32, v15
    ds_read_b64 v[164:165], v22
    s_waitcnt vmcnt(12)
    v_mfma_f32_32x32x16_bf16 v[48:63], a[180:183], a[24:27], v[48:63]
    v_mfma_f32_32x32x16_bf16 v[32:47], a[176:179], a[24:27], v[32:47]
    buffer_load_dwordx4 a[76:79], v6, s[16:19], s44 offen offset:3072 sc1
    v_xor_b32 v22, 48, v15
    ds_read_b64 v[166:167], v22
    s_waitcnt vmcnt(12)
    v_mfma_f32_32x32x16_bf16 v[48:63], a[188:191], a[28:31], v[48:63]
    v_mfma_f32_32x32x16_bf16 v[32:47], a[184:187], a[28:31], v[32:47]
    s_xor_b32 s54, s94, 5
    s_lshl_b32 s44, s54, 12
    s_add_u32 s44, s44, s43
    buffer_load_dwordx4 a[80:83], v6, s[16:19], s44 offen sc1
    s_waitcnt vmcnt(12)
    v_mfma_f32_32x32x16_bf16 v[48:63], a[196:199], a[32:35], v[48:63]
    v_mfma_f32_32x32x16_bf16 v[32:47], a[192:195], a[32:35], v[32:47]
    buffer_load_dwordx4 a[84:87], v6, s[16:19], s44 offen offset:1024 sc1
    s_waitcnt vmcnt(12)
    v_mfma_f32_32x32x16_bf16 v[48:63], a[204:207], a[36:39], v[48:63]
    v_mfma_f32_32x32x16_bf16 v[32:47], a[200:203], a[36:39], v[32:47]
    ds_read_b64_tr_b16 v[176:177], v12 offset:49152
    ds_read_b64_tr_b16 v[178:179], v12 offset:50176
    ds_read_b64_tr_b16 v[180:181], v13 offset:49152
    ds_read_b64_tr_b16 v[182:183], v13 offset:50176
    buffer_load_dwordx4 a[88:91], v6, s[16:19], s44 offen offset:2048 sc1
    s_waitcnt vmcnt(12)
    v_mfma_f32_32x32x16_bf16 v[48:63], a[212:215], a[40:43], v[48:63]
    v_mfma_f32_32x32x16_bf16 v[32:47], a[208:211], a[40:43], v[32:47]
    ds_read_b64_tr_b16 v[184:185], v12 offset:51200
    ds_read_b64_tr_b16 v[186:187], v12 offset:52224
    ds_read_b64_tr_b16 v[188:189], v13 offset:51200
    ds_read_b64_tr_b16 v[190:191], v13 offset:52224
    buffer_load_dwordx4 a[92:95], v6, s[16:19], s44 offen offset:3072 sc1
    s_waitcnt vmcnt(12)
    v_mfma_f32_32x32x16_bf16 v[48:63], a[220:223], a[44:47], v[48:63]
    v_mfma_f32_32x32x16_bf16 v[32:47], a[216:219], a[44:47], v[32:47]
    ds_read_b64_tr_b16 v[192:193], v12 offset:53248
    ds_read_b64_tr_b16 v[194:195], v12 offset:54272
    ds_read_b64_tr_b16 v[196:197], v13 offset:53248
    ds_read_b64_tr_b16 v[198:199], v13 offset:54272
    s_xor_b32 s54, s94, 6
    s_lshl_b32 s44, s54, 12
    s_add_u32 s44, s44, s43
    buffer_load_dwordx4 a[96:99], v6, s[16:19], s44 offen sc1
    s_waitcnt vmcnt(12) lgkmcnt(8)
    v_mfma_f32_32x32x16_bf16 v[48:63], v[180:183], a[48:51], v[48:63]
    v_mfma_f32_32x32x16_bf16 v[32:47], v[176:179], a[48:51], v[32:47]
    ds_read_b64_tr_b16 v[200:201], v12 offset:55296
    ds_read_b64_tr_b16 v[202:203], v12 offset:56320
    ds_read_b64_tr_b16 v[204:205], v13 offset:55296
    ds_read_b64_tr_b16 v[206:207], v13 offset:56320
    buffer_load_dwordx4 a[100:103], v6, s[16:19], s44 offen offset:1024 sc1
    s_waitcnt vmcnt(12) lgkmcnt(8)
    v_mfma_f32_32x32x16_bf16 v[48:63], v[188:191], a[52:55], v[48:63]
    v_mfma_f32_32x32x16_bf16 v[32:47], v[184:187], a[52:55], v[32:47]
    ds_read_b64_tr_b16 v[176:177], v20 offset:0
    ds_read_b64_tr_b16 v[178:179], v20 offset:1024
    ds_read_b64_tr_b16 v[180:181], v21 offset:0
    ds_read_b64_tr_b16 v[182:183], v21 offset:1024
    buffer_load_dwordx4 a[104:107], v6, s[16:19], s44 offen offset:2048 sc1
    s_waitcnt vmcnt(12) lgkmcnt(8)
    v_mfma_f32_32x32x16_bf16 v[48:63], v[196:199], a[56:59], v[48:63]
    v_mfma_f32_32x32x16_bf16 v[32:47], v[192:195], a[56:59], v[32:47]
    ds_read_b64_tr_b16 v[184:185], v20 offset:2048
    ds_read_b64_tr_b16 v[186:187], v20 offset:3072
    ds_read_b64_tr_b16 v[188:189], v21 offset:2048
    ds_read_b64_tr_b16 v[190:191], v21 offset:3072
    buffer_load_dwordx4 a[108:111], v6, s[16:19], s44 offen offset:3072 sc1
    s_waitcnt vmcnt(12) lgkmcnt(8)
    v_mfma_f32_32x32x16_bf16 v[48:63], v[204:207], a[60:63], v[48:63]
    v_mfma_f32_32x32x16_bf16 v[32:47], v[200:203], a[60:63], v[32:47]
    s_mov_b32 s36, 8916992
    buffer_load_dword v168, v7, s[20:23], s36 offen sc1
    ds_read_b64_tr_b16 v[192:193], v20 offset:4096
    ds_read_b64_tr_b16 v[194:195], v20 offset:5120
    ds_read_b64_tr_b16 v[196:197], v21 offset:4096
    ds_read_b64_tr_b16 v[198:199], v21 offset:5120
    s_xor_b32 s54, s94, 7
    s_lshl_b32 s44, s54, 12
    s_add_u32 s44, s44, s43
    buffer_load_dwordx4 a[112:115], v6, s[16:19], s44 offen sc1
    s_waitcnt vmcnt(13) lgkmcnt(8)
    v_mfma_f32_32x32x16_bf16 v[48:63], v[180:183], a[64:67], v[48:63]
    v_mfma_f32_32x32x16_bf16 v[32:47], v[176:179], a[64:67], v[32:47]
    ds_read_b64_tr_b16 v[200:201], v20 offset:6144
    ds_read_b64_tr_b16 v[202:203], v20 offset:7168
    ds_read_b64_tr_b16 v[204:205], v21 offset:6144
    ds_read_b64_tr_b16 v[206:207], v21 offset:7168
    buffer_load_dwordx4 a[116:119], v6, s[16:19], s44 offen offset:1024 sc1
    s_waitcnt vmcnt(13) lgkmcnt(8)
    v_mfma_f32_32x32x16_bf16 v[48:63], v[188:191], a[68:71], v[48:63]
    v_mfma_f32_32x32x16_bf16 v[32:47], v[184:187], a[68:71], v[32:47]
    ds_read_b64_tr_b16 v[176:177], v20 offset:16384
    ds_read_b64_tr_b16 v[178:179], v20 offset:17408
    ds_read_b64_tr_b16 v[180:181], v21 offset:16384
    ds_read_b64_tr_b16 v[182:183], v21 offset:17408
    buffer_load_dwordx4 a[120:123], v6, s[16:19], s44 offen offset:2048 sc1
    s_waitcnt vmcnt(13) lgkmcnt(8)
    v_mfma_f32_32x32x16_bf16 v[48:63], v[196:199], a[72:75], v[48:63]
    v_mfma_f32_32x32x16_bf16 v[32:47], v[192:195], a[72:75], v[32:47]
    v_lshlrev_b32 v112, 16, v160
    v_and_b32 v113, 0xffff0000, v160
    ds_read_b64_tr_b16 v[184:185], v20 offset:18432
    ds_read_b64_tr_b16 v[186:187], v20 offset:19456
    ds_read_b64_tr_b16 v[188:189], v21 offset:18432
    ds_read_b64_tr_b16 v[190:191], v21 offset:19456
    buffer_load_dwordx4 a[124:127], v6, s[16:19], s44 offen offset:3072 sc1
    s_waitcnt vmcnt(13) lgkmcnt(8)
    v_mfma_f32_32x32x16_bf16 v[48:63], v[204:207], a[76:79], v[48:63]
    v_mfma_f32_32x32x16_bf16 v[32:47], v[200:203], a[76:79], v[32:47]
    v_lshlrev_b32 v114, 16, v161
    v_and_b32 v115, 0xffff0000, v161
    ds_read_b64_tr_b16 v[192:193], v20 offset:20480
    ds_read_b64_tr_b16 v[194:195], v20 offset:21504
    ds_read_b64_tr_b16 v[196:197], v21 offset:20480
    ds_read_b64_tr_b16 v[198:199], v21 offset:21504
    s_and_b32 s54, s94, 1
    s_xor_b32 s54, s54, 8
    s_lshl_b32 s44, s54, 12
    s_add_u32 s44, s44, s43
    buffer_load_dwordx4 a[128:131], v6, s[16:19], s44 offen sc1
    s_waitcnt vmcnt(13) lgkmcnt(8)
    v_mfma_f32_32x32x16_bf16 v[48:63], v[180:183], a[80:83], v[48:63]
    v_mfma_f32_32x32x16_bf16 v[32:47], v[176:179], a[80:83], v[32:47]
    v_lshlrev_b32 v116, 16, v162
    v_and_b32 v117, 0xffff0000, v162
    ds_read_b64_tr_b16 v[200:201], v20 offset:22528
    ds_read_b64_tr_b16 v[202:203], v20 offset:23552
    ds_read_b64_tr_b16 v[204:205], v21 offset:22528
    ds_read_b64_tr_b16 v[206:207], v21 offset:23552
    buffer_load_dwordx4 a[132:135], v6, s[16:19], s44 offen offset:1024 sc1
    s_waitcnt vmcnt(13) lgkmcnt(8)
    v_mfma_f32_32x32x16_bf16 v[48:63], v[188:191], a[84:87], v[48:63]
    v_mfma_f32_32x32x16_bf16 v[32:47], v[184:187], a[84:87], v[32:47]
    v_lshlrev_b32 v118, 16, v163
    v_and_b32 v119, 0xffff0000, v163
    ds_read_b64_tr_b16 v[176:177], v20 offset:32768
    ds_read_b64_tr_b16 v[178:179], v20 offset:33792
    ds_read_b64_tr_b16 v[180:181], v21 offset:32768
    ds_read_b64_tr_b16 v[182:183], v21 offset:33792
    buffer_load_dwordx4 a[136:139], v6, s[16:19], s44 offen offset:2048 sc1
    s_waitcnt vmcnt(13) lgkmcnt(8)
    v_mfma_f32_32x32x16_bf16 v[48:63], v[196:199], a[88:91], v[48:63]
    v_mfma_f32_32x32x16_bf16 v[32:47], v[192:195], a[88:91], v[32:47]
    v_lshlrev_b32 v120, 16, v164
    v_and_b32 v121, 0xffff0000, v164
    ds_read_b64_tr_b16 v[184:185], v20 offset:34816
    ds_read_b64_tr_b16 v[186:187], v20 offset:35840
    ds_read_b64_tr_b16 v[188:189], v21 offset:34816
    ds_read_b64_tr_b16 v[190:191], v21 offset:35840
    buffer_load_dwordx4 a[140:143], v6, s[16:19], s44 offen offset:3072 sc1
    s_waitcnt vmcnt(13) lgkmcnt(8)
    v_mfma_f32_32x32x16_bf16 v[48:63], v[204:207], a[92:95], v[48:63]
    v_mfma_f32_32x32x16_bf16 v[32:47], v[200:203], a[92:95], v[32:47]
    v_lshlrev_b32 v122, 16, v165
    v_and_b32 v123, 0xffff0000, v165
    ds_read_b64_tr_b16 v[192:193], v20 offset:36864
    ds_read_b64_tr_b16 v[194:195], v20 offset:37888
    ds_read_b64_tr_b16 v[196:197], v21 offset:36864
    ds_read_b64_tr_b16 v[198:199], v21 offset:37888
    s_and_b32 s54, s94, 1
    s_xor_b32 s54, s54, 9
    s_lshl_b32 s44, s54, 12
    s_add_u32 s44, s44, s43
    buffer_load_dwordx4 a[144:147], v6, s[16:19], s44 offen sc1
    s_waitcnt vmcnt(13) lgkmcnt(8)
    v_mfma_f32_32x32x16_bf16 v[48:63], v[180:183], a[96:99], v[48:63]
    v_mfma_f32_32x32x16_bf16 v[32:47], v[176:179], a[96:99], v[32:47]
    v_lshlrev_b32 v124, 16, v166
    v_and_b32 v125, 0xffff0000, v166
    ds_read_b64_tr_b16 v[200:201], v20 offset:38912
    ds_read_b64_tr_b16 v[202:203], v20 offset:39936
    ds_read_b64_tr_b16 v[204:205], v21 offset:38912
    ds_read_b64_tr_b16 v[206:207], v21 offset:39936
    buffer_load_dwordx4 a[148:151], v6, s[16:19], s44 offen offset:1024 sc1
    s_waitcnt vmcnt(13) lgkmcnt(8)
    v_mfma_f32_32x32x16_bf16 v[48:63], v[188:191], a[100:103], v[48:63]
    v_mfma_f32_32x32x16_bf16 v[32:47], v[184:187], a[100:103], v[32:47]
    v_lshlrev_b32 v126, 16, v167
    v_and_b32 v127, 0xffff0000, v167
    ds_read_b64_tr_b16 v[176:177], v20 offset:49152
    ds_read_b64_tr_b16 v[178:179], v20 offset:50176
    ds_read_b64_tr_b16 v[180:181], v21 offset:49152
    ds_read_b64_tr_b16 v[182:183], v21 offset:50176
    buffer_load_dwordx4 a[152:155], v6, s[16:19], s44 offen offset:2048 sc1
    s_waitcnt vmcnt(13) lgkmcnt(8)
    v_mfma_f32_32x32x16_bf16 v[48:63], v[196:199], a[104:107], v[48:63]
    v_mfma_f32_32x32x16_bf16 v[32:47], v[192:195], a[104:107], v[32:47]
    ds_read_b64_tr_b16 v[184:185], v20 offset:51200
    ds_read_b64_tr_b16 v[186:187], v20 offset:52224
    ds_read_b64_tr_b16 v[188:189], v21 offset:51200
    ds_read_b64_tr_b16 v[190:191], v21 offset:52224
    buffer_load_dwordx4 a[156:159], v6, s[16:19], s44 offen offset:3072 sc1
    s_waitcnt vmcnt(13) lgkmcnt(8)
    v_mfma_f32_32x32x16_bf16 v[48:63], v[204:207], a[108:111], v[48:63]
    v_mfma_f32_32x32x16_bf16 v[32:47], v[200:203], a[108:111], v[32:47]
    s_waitcnt vmcnt(12)
    s_mov_b32 s53, 0
L_tpoll:
    v_cmp_eq_u32 vcc, s95, v168
    s_cmp_eq_u64 vcc, -1
    s_cbranch_scc1 L_tsync
    buffer_load_dword v168, v7, s[20:23], s36 offen sc1
    s_add_u32 s53, s53, 1
    s_waitcnt vmcnt(0)
    s_cmp_lt_u32 s53, 20000
    s_cbranch_scc1 L_tpoll
L_tsync:
    ds_read_b64_tr_b16 v[192:193], v20 offset:53248
    ds_read_b64_tr_b16 v[194:195], v20 offset:54272
    ds_read_b64_tr_b16 v[196:197], v21 offset:53248
    ds_read_b64_tr_b16 v[198:199], v21 offset:54272
    s_mov_b32 s54, 10
    s_lshl_b32 s44, s54, 12
    s_add_u32 s44, s44, s43
    buffer_load_dwordx4 a[160:163], v6, s[16:19], s44 offen sc1
    buffer_load_dwordx4 v[128:131], v14, s[20:23], s46 offen offset:0 sc1
    buffer_load_dwordx4 v[132:135], v14, s[20:23], s46 offen offset:1024 sc1
    s_waitcnt vmcnt(14) lgkmcnt(8)
    v_mfma_f32_32x32x16_bf16 v[48:63], v[180:183], a[112:115], v[48:63]
    v_mfma_f32_32x32x16_bf16 v[32:47], v[176:179], a[112:115], v[32:47]
    ds_read_b64_tr_b16 v[200:201], v20 offset:55296
    ds_read_b64_tr_b16 v[202:203], v20 offset:56320
    ds_read_b64_tr_b16 v[204:205], v21 offset:55296
    ds_read_b64_tr_b16 v[206:207], v21 offset:56320
    buffer_load_dwordx4 a[164:167], v6, s[16:19], s44 offen offset:1024 sc1
    buffer_load_dwordx4 v[136:139], v14, s[20:23], s46 offen offset:2048 sc1
    buffer_load_dwordx4 v[140:143], v14, s[20:23], s46 offen offset:3072 sc1
    s_waitcnt vmcnt(16) lgkmcnt(8)
    v_mfma_f32_32x32x16_bf16 v[48:63], v[188:191], a[116:119], v[48:63]
    v_mfma_f32_32x32x16_bf16 v[32:47], v[184:187], a[116:119], v[32:47]
    ds_read_b64_tr_b16 v[176:177], v12 offset:0
    ds_read_b64_tr_b16 v[178:179], v12 offset:1024
    ds_read_b64_tr_b16 v[180:181], v13 offset:0
    ds_read_b64_tr_b16 v[182:183], v13 offset:1024
    buffer_load_dwordx4 a[168:171], v6, s[16:19], s44 offen offset:2048 sc1
    buffer_load_dwordx4 v[144:147], v14, s[20:23], s52 offen offset:0 sc1
    buffer_load_dwordx4 v[148:151], v14, s[20:23], s52 offen offset:1024 sc1
    s_waitcnt vmcnt(18) lgkmcnt(8)
    v_mfma_f32_32x32x16_bf16 v[48:63], v[196:199], a[120:123], v[48:63]
    v_mfma_f32_32x32x16_bf16 v[32:47], v[192:195], a[120:123], v[32:47]
    ds_read_b64_tr_b16 v[184:185], v12 offset:2048
    ds_read_b64_tr_b16 v[186:187], v12 offset:3072
    ds_read_b64_tr_b16 v[188:189], v13 offset:2048
    ds_read_b64_tr_b16 v[190:191], v13 offset:3072
    buffer_load_dwordx4 a[172:175], v6, s[16:19], s44 offen offset:3072 sc1
    buffer_load_dwordx4 v[152:155], v14, s[20:23], s52 offen offset:2048 sc1
    buffer_load_dwordx4 v[156:159], v14, s[20:23], s52 offen offset:3072 sc1
    s_waitcnt vmcnt(20) lgkmcnt(8)
    v_mfma_f32_32x32x16_bf16 v[48:63], v[204:207], a[124:127], v[48:63]
    v_mfma_f32_32x32x16_bf16 v[32:47], v[200:203], a[124:127], v[32:47]
    ds_read_b64_tr_b16 v[192:193], v12 offset:4096
    ds_read_b64_tr_b16 v[194:195], v12 offset:5120
    ds_read_b64_tr_b16 v[196:197], v13 offset:4096
    ds_read_b64_tr_b16 v[198:199], v13 offset:5120
    s_waitcnt vmcnt(19) lgkmcnt(8)
    v_mfma_f32_32x32x16_bf16 v[48:63], v[180:183], a[128:131], v[48:63]
    v_mfma_f32_32x32x16_bf16 v[32:47], v[176:179], a[128:131], v[32:47]
    ds_read_b64_tr_b16 v[200:201], v12 offset:6144
    ds_read_b64_tr_b16 v[202:203], v12 offset:7168
    ds_read_b64_tr_b16 v[204:205], v13 offset:6144
    ds_read_b64_tr_b16 v[206:207], v13 offset:7168
    s_waitcnt vmcnt(18) lgkmcnt(8)
    v_mfma_f32_32x32x16_bf16 v[48:63], v[188:191], a[132:135], v[48:63]
    v_mfma_f32_32x32x16_bf16 v[32:47], v[184:187], a[132:135], v[32:47]
    ds_read_b64_tr_b16 v[176:177], v12 offset:16384
    ds_read_b64_tr_b16 v[178:179], v12 offset:17408
    ds_read_b64_tr_b16 v[180:181], v13 offset:16384
    ds_read_b64_tr_b16 v[182:183], v13 offset:17408
    s_waitcnt vmcnt(17) lgkmcnt(8)
    v_mfma_f32_32x32x16_bf16 v[48:63], v[196:199], a[136:139], v[48:63]
    v_mfma_f32_32x32x16_bf16 v[32:47], v[192:195], a[136:139], v[32:47]
    ds_read_b64_tr_b16 v[184:185], v12 offset:18432
    ds_read_b64_tr_b16 v[186:187], v12 offset:19456
    ds_read_b64_tr_b16 v[188:189], v13 offset:18432
    ds_read_b64_tr_b16 v[190:191], v13 offset:19456
    s_waitcnt vmcnt(16) lgkmcnt(8)
    v_mfma_f32_32x32x16_bf16 v[48:63], v[204:207], a[140:143], v[48:63]
    v_mfma_f32_32x32x16_bf16 v[32:47], v[200:203], a[140:143], v[32:47]
    ds_read_b64_tr_b16 v[192:193], v12 offset:20480
    ds_read_b64_tr_b16 v[194:195], v12 offset:21504
    ds_read_b64_tr_b16 v[196:197], v13 offset:20480
    ds_read_b64_tr_b16 v[198:199], v13 offset:21504
    s_waitcnt vmcnt(15) lgkmcnt(8)
    v_mfma_f32_32x32x16_bf16 v[48:63], v[180:183], a[144:147], v[48:63]
    v_mfma_f32_32x32x16_bf16 v[32:47], v[176:179], a[144:147], v[32:47]
    ds_read_b64_tr_b16 v[200:201], v12 offset:22528
    ds_read_b64_tr_b16 v[202:203], v12 offset:23552
    ds_read_b64_tr_b16 v[204:205], v13 offset:22528
    ds_read_b64_tr_b16 v[206:207], v13 offset:23552
    s_waitcnt vmcnt(14) lgkmcnt(8)
    v_mfma_f32_32x32x16_bf16 v[48:63], v[188:191], a[148:151], v[48:63]
    v_mfma_f32_32x32x16_bf16 v[32:47], v[184:187], a[148:151], v[32:47]
    ds_read_b64_tr_b16 v[176:177], v12 offset:32768
    ds_read_b64_tr_b16 v[178:179], v12 offset:33792
    ds_read_b64_tr_b16 v[180:181], v13 offset:32768
    ds_read_b64_tr_b16 v[182:183], v13 offset:33792
    s_waitcnt vmcnt(13) lgkmcnt(8)
    v_mfma_f32_32x32x16_bf16 v[48:63], v[196:199], a[152:155], v[48:63]
    v_mfma_f32_32x32x16_bf16 v[32:47], v[192:195], a[152:155], v[32:47]
    ds_read_b64_tr_b16 v[184:185], v12 offset:34816
    ds_read_b64_tr_b16 v[186:187], v12 offset:35840
    ds_read_b64_tr_b16 v[188:189], v13 offset:34816
    ds_read_b64_tr_b16 v[190:191], v13 offset:35840
    s_waitcnt vmcnt(12) lgkmcnt(8)
    v_mfma_f32_32x32x16_bf16 v[48:63], v[204:207], a[156:159], v[48:63]
    v_mfma_f32_32x32x16_bf16 v[32:47], v[200:203], a[156:159], v[32:47]
    ds_read_b64_tr_b16 v[192:193], v12 offset:36864
    ds_read_b64_tr_b16 v[194:195], v12 offset:37888
    ds_read_b64_tr_b16 v[196:197], v13 offset:36864
    ds_read_b64_tr_b16 v[198:199], v13 offset:37888
    s_waitcnt vmcnt(11) lgkmcnt(8)
    v_mfma_f32_32x32x16_bf16 v[48:63], v[180:183], a[160:163], v[48:63]
    v_mfma_f32_32x32x16_bf16 v[32:47], v[176:179], a[160:163], v[32:47]
    ds_read_b64_tr_b16 v[200:201], v12 offset:38912
    ds_read_b64_tr_b16 v[202:203], v12 offset:39936
    ds_read_b64_tr_b16 v[204:205], v13 offset:38912
    ds_read_b64_tr_b16 v[206:207], v13 offset:39936
    s_waitcnt vmcnt(8) lgkmcnt(8)
    v_mfma_f32_32x32x16_bf16 v[48:63], v[188:191], a[164:167], v[48:63]
    v_mfma_f32_32x32x16_bf16 v[32:47], v[184:187], a[164:167], v[32:47]
    s_waitcnt vmcnt(5) lgkmcnt(4)
    v_mfma_f32_32x32x16_bf16 v[48:63], v[196:199], a[168:171], v[48:63]
    v_mfma_f32_32x32x16_bf16 v[32:47], v[192:195], a[168:171], v[32:47]
    s_waitcnt vmcnt(2) lgkmcnt(0)
    v_mfma_f32_32x32x16_bf16 v[48:63], v[204:207], a[172:175], v[48:63]
    v_mfma_f32_32x32x16_bf16 v[32:47], v[200:203], a[172:175], v[32:47]
    s_waitcnt vmcnt(0)
    v_mfma_f32_32x32x16_bf16 v[96:111], v[128:131], v[64:67], 0
    v_mfma_f32_32x32x16_bf16 v[96:111], v[132:135], v[68:71], v[96:111]
    s_mov_b32 s48, 0xbfb8aa3b
    s_mov_b32 s49, 0xbfb8aa3b
    v_xor_b32 v2, 8192, v16
    s_nop 5
    ds_write_b128 v16, v[48:51] offset:0
    v_mfma_f32_32x32x16_bf16 v[96:111], v[136:139], v[72:75], v[96:111]
    ds_write_b128 v16, v[52:55] offset:1024
    v_mfma_f32_32x32x16_bf16 v[96:111], v[140:143], v[76:79], v[96:111]
    ds_write_b128 v16, v[56:59] offset:2048
    v_mfma_f32_32x32x16_bf16 v[96:111], v[144:147], v[80:83], v[96:111]
    ds_write_b128 v16, v[60:63] offset:3072
    v_mfma_f32_32x32x16_bf16 v[96:111], v[148:151], v[84:87], v[96:111]
    v_mfma_f32_32x32x16_bf16 v[96:111], v[152:155], v[88:91], v[96:111]
    v_mfma_f32_32x32x16_bf16 v[96:111], v[156:159], v[92:95], v[96:111]
    s_waitcnt lgkmcnt(0)
    s_barrier
    ds_read_b128 v[48:51], v2 offset:0
    ds_read_b128 v[52:55], v2 offset:1024
    ds_read_b128 v[56:59], v2 offset:2048
    ds_read_b128 v[60:63], v2 offset:3072
    s_waitcnt lgkmcnt(3)
    v_pk_add_f32 v[32:33], v[32:33], v[48:49]
    v_pk_add_f32 v[34:35], v[34:35], v[50:51]
    v_pk_mul_f32 v[128:129], v[32:33], s[48:49]
    v_pk_mul_f32 v[130:131], v[34:35], s[48:49]
    v_exp_f32 v128, v128
    v_exp_f32 v129, v129
    v_exp_f32 v130, v130
    v_exp_f32 v131, v131
    v_cndmask_b32 v96, v96, 0, s[50:51]
    v_pk_mul_f32 v[32:33], v[32:33], v[96:97]
    v_pk_mul_f32 v[34:35], v[34:35], v[98:99]
    v_pk_add_f32 v[128:129], v[128:129], 1.0 op_sel_hi:[1,0]
    v_pk_add_f32 v[130:131], v[130:131], 1.0 op_sel_hi:[1,0]
    v_rcp_f32 v128, v128
    v_rcp_f32 v129, v129
    v_rcp_f32 v130, v130
    v_rcp_f32 v131, v131
    s_waitcnt lgkmcnt(2)
    v_pk_add_f32 v[36:37], v[36:37], v[52:53]
    v_pk_add_f32 v[38:39], v[38:39], v[54:55]
    v_pk_mul_f32 v[132:133], v[36:37], s[48:49]
    v_pk_mul_f32 v[134:135], v[38:39], s[48:49]
    v_exp_f32 v132, v132
    v_exp_f32 v133, v133
    v_exp_f32 v134, v134
    v_exp_f32 v135, v135
    v_pk_mul_f32 v[36:37], v[36:37], v[100:101]
    v_pk_mul_f32 v[38:39], v[38:39], v[102:103]
    v_pk_add_f32 v[132:133], v[132:133], 1.0 op_sel_hi:[1,0]
    v_pk_add_f32 v[134:135], v[134:135], 1.0 op_sel_hi:[1,0]
    v_rcp_f32 v132, v132
    v_rcp_f32 v133, v133
    v_rcp_f32 v134, v134
    v_rcp_f32 v135, v135
    v_pk_fma_f32 v[32:33], v[32:33], v[128:129], v[112:113]
    v_pk_fma_f32 v[34:35], v[34:35], v[130:131], v[114:115]
    v_cvt_pk_bf16_f32 v160, v32, v33
    v_cvt_pk_bf16_f32 v161, v34, v35
    v_pk_fma_f32 v[36:37], v[36:37], v[132:133], v[116:117]
    v_pk_fma_f32 v[38:39], v[38:39], v[134:135], v[118:119]
    v_cvt_pk_bf16_f32 v162, v36, v37
    v_cvt_pk_bf16_f32 v163, v38, v39
    s_nop 1
    v_permlane32_swap_b32 v160, v162
    v_permlane32_swap_b32 v161, v163
    buffer_store_dwordx4 v[160:163], v27, s[12:15], s47 offen offset:0
    s_waitcnt lgkmcnt(1)
    v_pk_add_f32 v[40:41], v[40:41], v[56:57]
    v_pk_add_f32 v[42:43], v[42:43], v[58:59]
    v_pk_mul_f32 v[136:137], v[40:41], s[48:49]
    v_pk_mul_f32 v[138:139], v[42:43], s[48:49]
    v_exp_f32 v136, v136
    v_exp_f32 v137, v137
    v_exp_f32 v138, v138
    v_exp_f32 v139, v139
    v_pk_mul_f32 v[40:41], v[40:41], v[104:105]
    v_pk_mul_f32 v[42:43], v[42:43], v[106:107]
    v_pk_add_f32 v[136:137], v[136:137], 1.0 op_sel_hi:[1,0]
    v_pk_add_f32 v[138:139], v[138:139], 1.0 op_sel_hi:[1,0]
    v_rcp_f32 v136, v136
    v_rcp_f32 v137, v137
    v_rcp_f32 v138, v138
    v_rcp_f32 v139, v139
    s_waitcnt lgkmcnt(0)
    v_pk_add_f32 v[44:45], v[44:45], v[60:61]
    v_pk_add_f32 v[46:47], v[46:47], v[62:63]
    v_pk_mul_f32 v[140:141], v[44:45], s[48:49]
    v_pk_mul_f32 v[142:143], v[46:47], s[48:49]
    v_exp_f32 v140, v140
    v_exp_f32 v141, v141
    v_exp_f32 v142, v142
    v_exp_f32 v143, v143
    v_pk_mul_f32 v[44:45], v[44:45], v[108:109]
    v_pk_mul_f32 v[46:47], v[46:47], v[110:111]
    v_pk_add_f32 v[140:141], v[140:141], 1.0 op_sel_hi:[1,0]
    v_pk_add_f32 v[142:143], v[142:143], 1.0 op_sel_hi:[1,0]
    v_rcp_f32 v140, v140
    v_rcp_f32 v141, v141
    v_rcp_f32 v142, v142
    v_rcp_f32 v143, v143
    v_pk_fma_f32 v[40:41], v[40:41], v[136:137], v[120:121]
    v_pk_fma_f32 v[42:43], v[42:43], v[138:139], v[122:123]
    v_cvt_pk_bf16_f32 v164, v40, v41
    v_cvt_pk_bf16_f32 v165, v42, v43
    v_pk_fma_f32 v[44:45], v[44:45], v[140:141], v[124:125]
    v_pk_fma_f32 v[46:47], v[46:47], v[142:143], v[126:127]
    v_cvt_pk_bf16_f32 v166, v44, v45
    v_cvt_pk_bf16_f32 v167, v46, v47
    s_nop 1
    v_permlane32_swap_b32 v164, v166
    v_permlane32_swap_b32 v165, v167
    buffer_store_dwordx4 v[164:167], v27, s[12:15], s47 offen offset:32
    s_endpgm
K1_dft_main:
    s_mov_b32 s22, 9437184
    s_mov_b32 s23, 0x20000
    s_mov_b32 s36, 8921088
    buffer_load_dword v6, off, s[20:23], s36 sc1
    s_add_u32 s36, s33, s40
    s_mul_i32 s37, s36, 21846
    s_lshr_b32 s37, s37, 16
    s_mul_i32 s37, s37, 3
    s_sub_u32 s36, s36, s37
    s_add_u32 s36, s36, 1
    s_lshl_b32 s53, s36, 7
    s_cmp_eq_u32 s36, 3
    s_cselect_b32 s36, 0, s36
    s_add_u32 s36, s36, 1
    s_lshl_b32 s54, s36, 7
    s_cmp_eq_u32 s36, 3
    s_cselect_b32 s36, 0, s36
    s_add_u32 s36, s36, 1
    s_lshl_b32 s55, s36, 7
    s_cmp_eq_u32 s36, 3
    s_cselect_b32 s36, 0, s36
    s_add_u32 m0, s43, 32768
    s_add_u32 s38, s41, s53
    buffer_load_dwordx4 v8, s[8:11], s38 offen lds
    buffer_load_dwordx4 v9, s[8:11], s38 offen offset:1024 lds
    buffer_load_dwordx4 v10, s[8:11], s38 offen offset:2048 lds
    buffer_load_dwordx4 v11, s[8:11], s38 offen offset:3072 lds
    s_add_u32 m0, s43, 49152
    s_add_u32 s38, s45, s53
    buffer_load_dwordx4 v8, s[8:11], s38 offen lds
    buffer_load_dwordx4 v9, s[8:11], s38 offen offset:1024 lds
    buffer_load_dwordx4 v10, s[8:11], s38 offen offset:2048 lds
    buffer_load_dwordx4 v11, s[8:11], s38 offen offset:3072 lds
    s_mov_b32 s6, 1409024
    s_mov_b32 s7, 0x20000
    s_bfe_u32 s99, s2, 0x20003
    s_and_b32 s36, s2, 7
    s_lshl_b32 s36, s36, 2
    s_add_u32 s99, s99, s36
    s_lshr_b32 s100, s2, 5
    s_lshr_b32 s36, s32, 1
    s_and_b32 s37, s32, 1
    s_mul_i32 s92, s36, 720896
    s_lshl_b32 s38, s37, 15
    s_add_u32 s92, s92, s38
    s_lshl_b32 s38, s100, 7
    s_add_u32 s92, s92, s38
    s_lshl_b32 s93, s36, 13
    s_lshl_b32 s38, s37, 12
    s_add_u32 s93, s93, s38
    s_and_b32 s94, s100, 3
    s_lshl_b32 s98, s33, 7
    s_lshl_b32 s38, s34, 2
    s_add_u32 s98, s98, s38
    s_add_u32 s98, s98, 8912896
    s_lshr_b32 s3, s2, 3
    s_mul_i32 s3, s3, 44032
    s_lshl_b32 s38, s32, 8
    s_add_u32 s3, s3, s38
    v_lshlrev_b32 v7, 10, v1
    v_cmp_gt_u32 vcc, 22, v1
    s_nop 1
    v_cndmask_b32 v7, -1, v7, vcc
    v_lshrrev_b32 v2, 1, v1
    v_and_b32 v3, 1, v1
    v_lshlrev_b32 v3, 4, v3
    v_mul_u32_u24 v26, 2752, v2
    v_add_u32 v26, v26, v3
    v_xor_b32 v2, 4, v2
    v_mul_u32_u24 v27, 2752, v2
    v_add_u32 v27, v27, v3
    s_mul_i32 s48, s32, 352256
    s_lshl_b32 s36, s40, 5
    s_add_u32 s48, s48, s36
    s_add_u32 s48, s48, 2688
    s_add_u32 s49, s43, 98304
    s_cmp_eq_u32 s40, 0
    s_cselect_b32 s46, 1.0, -1.0
    s_mov_b32 s50, 0x80008000
    v_and_b32 v2, 31, v1
    v_lshrrev_b32 v3, 5, v1
    v_bfe_u32 v4, v1, 1, 3
    v_xor_b32 v4, v4, v3
    v_lshlrev_b32 v4, 4, v4
    v_lshl_add_u32 v4, v2, 7, v4
    v_add_u32 v16, s43, v4
    v_xor_b32 v17, 32, v16
    v_xor_b32 v18, 64, v16
    v_xor_b32 v19, 96, v16
    v_add_u32 v20, 65536, v4
    v_xor_b32 v21, 32, v20
    v_xor_b32 v22, 64, v20
    v_xor_b32 v23, 96, v20
    v_and_b32 v4, 31, v1
    v_mov_b32 v29, s39
    v_cmp_eq_u32 vcc, 0, v4
    v_cmp_eq_u32 s[62:63], 20, v4
    s_nop 0
    s_or_b64 vcc, vcc, s[62:63]
    s_nop 1
    v_cndmask_b32 v28, 0, v29, vcc
    v_mov_b32 v29, v28
    v_mov_b32 v30, v28
    v_mov_b32 v31, v28
    v_lshlrev_b32 v4, 2, v3
    v_mul_u32_u24 v4, v4, v2
    v_lshlrev_b32 v5, 2, v2
    s_mov_b32 s36, 0x3d000000
    v_and_b32 v56, 31, v4
    v_add_u32 v4, v4, v2
    v_cvt_f32_u32 v56, v56
    v_mul_f32 v56, s36, v56
    v_sin_f32 v60, v56
    v_cos_f32 v56, v56
    v_and_b32 v57, 31, v4
    v_add_u32 v4, v4, v2
    v_cvt_f32_u32 v57, v57
    v_mul_f32 v57, s36, v57
    v_sin_f32 v61, v57
    v_cos_f32 v57, v57
    v_and_b32 v58, 31, v4
    v_add_u32 v4, v4, v2
    v_cvt_f32_u32 v58, v58
    v_mul_f32 v58, s36, v58
    v_sin_f32 v62, v58
    v_cos_f32 v58, v58
    v_and_b32 v59, 31, v4
    v_add_u32 v4, v4, v2
    v_cvt_f32_u32 v59, v59
    v_mul_f32 v59, s36, v59
    v_sin_f32 v63, v59
    v_cos_f32 v59, v59
    v_add_u32 v4, v4, v5
    v_cvt_pk_bf16_f32 v56, v56, v57
    v_cvt_pk_bf16_f32 v60, v60, v61
    v_accvgpr_write_b32 a132, v56
    v_accvgpr_write_b32 a164, v60
    v_xor_b32 v60, s50, v60
    v_accvgpr_write_b32 a140, v60
    v_cvt_pk_bf16_f32 v58, v58, v59
    v_cvt_pk_bf16_f32 v62, v62, v63
    v_accvgpr_write_b32 a133, v58
    v_accvgpr_write_b32 a165, v62
    v_xor_b32 v62, s50, v62
    v_accvgpr_write_b32 a141, v62
    v_and_b32 v56, 31, v4
    v_add_u32 v4, v4, v2
    v_cvt_f32_u32 v56, v56
    v_mul_f32 v56, s36, v56
    v_sin_f32 v60, v56
    v_cos_f32 v56, v56
    v_and_b32 v57, 31, v4
    v_add_u32 v4, v4, v2
    v_cvt_f32_u32 v57, v57
    v_mul_f32 v57, s36, v57
    v_sin_f32 v61, v57
    v_cos_f32 v57, v57
    v_and_b32 v58, 31, v4
    v_add_u32 v4, v4, v2
    v_cvt_f32_u32 v58, v58
    v_mul_f32 v58, s36, v58
    v_sin_f32 v62, v58
    v_cos_f32 v58, v58
    v_and_b32 v59, 31, v4
    v_add_u32 v4, v4, v2
    v_cvt_f32_u32 v59, v59
    v_mul_f32 v59, s36, v59
    v_sin_f32 v63, v59
    v_cos_f32 v59, v59
    v_add_u32 v4, v4, v5
    v_cvt_pk_bf16_f32 v56, v56, v57
    v_cvt_pk_bf16_f32 v60, v60, v61
    v_accvgpr_write_b32 a134, v56
    v_accvgpr_write_b32 a166, v60
    v_xor_b32 v60, s50, v60
    v_accvgpr_write_b32 a142, v60
    v_cvt_pk_bf16_f32 v58, v58, v59
    v_cvt_pk_bf16_f32 v62, v62, v63
    v_accvgpr_write_b32 a135, v58
    v_accvgpr_write_b32 a167, v62
    v_xor_b32 v62, s50, v62
    v_accvgpr_write_b32 a143, v62
    v_and_b32 v56, 31, v4
    v_add_u32 v4, v4, v2
    v_cvt_f32_u32 v56, v56
    v_mul_f32 v56, s36, v56
    v_sin_f32 v60, v56
    v_cos_f32 v56, v56
    v_and_b32 v57, 31, v4
    v_add_u32 v4, v4, v2
    v_cvt_f32_u32 v57, v57
    v_mul_f32 v57, s36, v57
    v_sin_f32 v61, v57
    v_cos_f32 v57, v57
    v_and_b32 v58, 31, v4
    v_add_u32 v4, v4, v2
    v_cvt_f32_u32 v58, v58
    v_mul_f32 v58, s36, v58
    v_sin_f32 v62, v58
    v_cos_f32 v58, v58
    v_and_b32 v59, 31, v4
    v_add_u32 v4, v4, v2
    v_cvt_f32_u32 v59, v59
    v_mul_f32 v59, s36, v59
    v_sin_f32 v63, v59
    v_cos_f32 v59, v59
    v_add_u32 v4, v4, v5
    v_cvt_pk_bf16_f32 v56, v56, v57
    v_cvt_pk_bf16_f32 v60, v60, v61
    v_accvgpr_write_b32 a136, v56
    v_accvgpr_write_b32 a168, v60
    v_xor_b32 v60, s50, v60
    v_accvgpr_write_b32 a144, v60
    v_cvt_pk_bf16_f32 v58, v58, v59
    v_cvt_pk_bf16_f32 v62, v62, v63
    v_accvgpr_write_b32 a137, v58
    v_accvgpr_write_b32 a169, v62
    v_xor_b32 v62, s50, v62
    v_accvgpr_write_b32 a145, v62
    v_and_b32 v56, 31, v4
    v_add_u32 v4, v4, v2
    v_cvt_f32_u32 v56, v56
    v_mul_f32 v56, s36, v56
    v_sin_f32 v60, v56
    v_cos_f32 v56, v56
    v_and_b32 v57, 31, v4
    v_add_u32 v4, v4, v2
    v_cvt_f32_u32 v57, v57
    v_mul_f32 v57, s36, v57
    v_sin_f32 v61, v57
    v_cos_f32 v57, v57
    v_and_b32 v58, 31, v4
    v_add_u32 v4, v4, v2
    v_cvt_f32_u32 v58, v58
    v_mul_f32 v58, s36, v58
    v_sin_f32 v62, v58
    v_cos_f32 v58, v58
    v_and_b32 v59, 31, v4
    v_add_u32 v4, v4, v2
    v_cvt_f32_u32 v59, v59
    v_mul_f32 v59, s36, v59
    v_sin_f32 v63, v59
    v_cos_f32 v59, v59
    v_add_u32 v4, v4, v5
    v_cvt_pk_bf16_f32 v56, v56, v57
    v_cvt_pk_bf16_f32 v60, v60, v61
    v_accvgpr_write_b32 a138, v56
    v_accvgpr_write_b32 a170, v60
    v_xor_b32 v60, s50, v60
    v_accvgpr_write_b32 a146, v60
    v_cvt_pk_bf16_f32 v58, v58, v59
    v_cvt_pk_bf16_f32 v62, v62, v63
    v_accvgpr_write_b32 a139, v58
    v_accvgpr_write_b32 a171, v62
    v_xor_b32 v62, s50, v62
    v_accvgpr_write_b32 a147, v62
    s_waitcnt vmcnt(17)
    ds_read_b128 v[32:35], v16 offset:0
    ds_read_b128 v[36:39], v16 offset:16384
    ds_read_b128 a[0:3], v16 offset:0
    ds_read_b128 a[64:67], v16 offset:16384
    ds_read_b128 v[40:43], v17 offset:0
    ds_read_b128 v[44:47], v17 offset:16384
    ds_read_b128 a[4:7], v17 offset:0
    ds_read_b128 a[68:71], v17 offset:16384
    s_waitcnt lgkmcnt(4)
    v_mfma_f32_16x16x32_bf16 a[128:131], v[28:31], v[32:35], 0
    v_mfma_f32_16x16x32_bf16 a[128:131], v[28:31], v[36:39], a[128:131]
    v_mfma_f32_32x32x16_bf16 a[148:163], v[32:35], v[32:35], 0
    v_mfma_f32_32x32x16_bf16 a[148:163], v[36:39], v[36:39], a[148:163]
    v_lshlrev_b32 v56, 16, v32
    v_and_b32 v57, 0xffff0000, v32
    v_lshlrev_b32 v58, 16, v36
    v_and_b32 v59, 0xffff0000, v36
    v_fmac_f32 v56, s46, v58
    v_fmac_f32 v57, s46, v59
    v_cvt_pk_bf16_f32 v48, v56, v57
    v_lshlrev_b32 v60, 16, v33
    v_and_b32 v61, 0xffff0000, v33
    v_lshlrev_b32 v62, 16, v37
    v_and_b32 v63, 0xffff0000, v37
    v_fmac_f32 v60, s46, v62
    v_fmac_f32 v61, s46, v63
    v_cvt_pk_bf16_f32 v49, v60, v61
    v_lshlrev_b32 v56, 16, v34
    v_and_b32 v57, 0xffff0000, v34
    v_lshlrev_b32 v58, 16, v38
    v_and_b32 v59, 0xffff0000, v38
    v_fmac_f32 v56, s46, v58
    v_fmac_f32 v57, s46, v59
    v_cvt_pk_bf16_f32 v50, v56, v57
    v_lshlrev_b32 v60, 16, v35
    v_and_b32 v61, 0xffff0000, v35
    v_lshlrev_b32 v62, 16, v39
    v_and_b32 v63, 0xffff0000, v39
    v_fmac_f32 v60, s46, v62
    v_fmac_f32 v61, s46, v63
    v_cvt_pk_bf16_f32 v51, v60, v61
    s_waitcnt vmcnt(9)
    s_barrier
    ds_read_b128 v[64:67], v20 offset:0
    ds_read_b128 v[68:71], v20 offset:4096
    ds_read_b128 v[72:75], v20 offset:8192
    ds_read_b128 v[76:79], v20 offset:12288
    ds_read_b128 v[80:83], v20 offset:16384
    ds_read_b128 v[84:87], v20 offset:20480
    ds_read_b128 v[88:91], v20 offset:24576
    ds_read_b128 v[92:95], v20 offset:28672
    s_waitcnt lgkmcnt(0)
    s_nop 1
    v_mfma_f32_32x32x16_bf16 v[128:143], v[48:51], v[64:67], 0
    s_add_u32 m0, s44, 32768
    s_nop 0
    buffer_load_dwordx4 v12, s[24:27], s53 offen lds
    ds_read_b128 v[96:99], v21 offset:0
    ds_read_b128 v[100:103], v21 offset:4096
    v_mfma_f32_32x32x16_bf16 v[144:159], v[48:51], v[68:71], 0
    buffer_load_dwordx4 v13, s[24:27], s53 offen offset:1024 lds
    ds_read_b128 v[104:107], v21 offset:8192
    ds_read_b128 v[108:111], v21 offset:12288
    v_lshlrev_b32 v56, 16, v40
    v_and_b32 v57, 0xffff0000, v40
    v_mfma_f32_32x32x16_bf16 v[160:175], v[48:51], v[72:75], 0
    ds_read_b128 v[112:115], v21 offset:16384
    ds_read_b128 v[116:119], v21 offset:20480
    v_lshlrev_b32 v58, 16, v44
    v_and_b32 v59, 0xffff0000, v44
    v_fmac_f32 v56, s46, v58
    v_mfma_f32_16x16x32_bf16 a[128:131], v[28:31], v[40:43], a[128:131]
    buffer_load_dwordx4 v14, s[24:27], s53 offen offset:2048 lds
    v_mfma_f32_32x32x16_bf16 a[148:163], v[40:43], v[40:43], a[148:163]
    ds_read_b128 v[120:123], v21 offset:24576
    ds_read_b128 v[124:127], v21 offset:28672
    v_fmac_f32 v57, s46, v59
    v_cvt_pk_bf16_f32 v52, v56, v57
    v_lshlrev_b32 v60, 16, v41
    v_mfma_f32_32x32x16_bf16 v[176:191], v[48:51], v[76:79], 0
    buffer_load_dwordx4 v15, s[24:27], s53 offen offset:3072 lds
    ds_read_b128 v[32:35], v18 offset:0
    ds_read_b128 v[36:39], v18 offset:16384
    v_and_b32 v61, 0xffff0000, v41
    v_lshlrev_b32 v62, 16, v45
    v_mfma_f32_32x32x16_bf16 v[192:207], v[48:51], v[80:83], 0
    ds_read_b128 a[8:11], v18 offset:0
    ds_read_b128 a[72:75], v18 offset:16384
    v_and_b32 v63, 0xffff0000, v45
    v_fmac_f32 v60, s46, v62
    v_fmac_f32 v61, s46, v63
    v_mfma_f32_32x32x16_bf16 v[208:223], v[48:51], v[84:87], 0
    s_add_u32 m0, s44, 36864
    s_nop 0
    buffer_load_dwordx4 v12, s[28:31], s53 offen lds
    v_cvt_pk_bf16_f32 v53, v60, v61
    v_lshlrev_b32 v56, 16, v42
    v_mfma_f32_16x16x32_bf16 a[128:131], v[28:31], v[44:47], a[128:131]
    buffer_load_dwordx4 v13, s[28:31], s53 offen offset:1024 lds
    v_mfma_f32_32x32x16_bf16 a[148:163], v[44:47], v[44:47], a[148:163]
    v_and_b32 v57, 0xffff0000, v42
    v_lshlrev_b32 v58, 16, v46
    v_and_b32 v59, 0xffff0000, v46
    v_fmac_f32 v56, s46, v58
    v_fmac_f32 v57, s46, v59
    v_mfma_f32_32x32x16_bf16 v[224:239], v[48:51], v[88:91], 0
    buffer_load_dwordx4 v14, s[28:31], s53 offen offset:2048 lds
    v_cvt_pk_bf16_f32 v54, v56, v57
    v_lshlrev_b32 v60, 16, v43
    v_and_b32 v61, 0xffff0000, v43
    v_lshlrev_b32 v62, 16, v47
    v_mfma_f32_32x32x16_bf16 v[240:255], v[48:51], v[92:95], 0
    v_and_b32 v63, 0xffff0000, v47
    v_fmac_f32 v60, s46, v62
    v_fmac_f32 v61, s46, v63
    v_cvt_pk_bf16_f32 v55, v60, v61
    s_waitcnt lgkmcnt(0)
    s_nop 1
    v_mfma_f32_32x32x16_bf16 v[128:143], v[52:55], v[96:99], v[128:143]
    buffer_load_dwordx4 v15, s[28:31], s53 offen offset:3072 lds
    ds_read_b128 v[64:67], v22 offset:0
    ds_read_b128 v[68:71], v22 offset:4096
    v_lshlrev_b32 v56, 16, v32
    v_and_b32 v57, 0xffff0000, v32
    v_mfma_f32_32x32x16_bf16 v[144:159], v[52:55], v[100:103], v[144:159]
    ds_read_b128 v[72:75], v22 offset:8192
    ds_read_b128 v[76:79], v22 offset:12288
    v_lshlrev_b32 v58, 16, v36
    v_and_b32 v59, 0xffff0000, v36
    v_fmac_f32 v56, s46, v58
    v_mfma_f32_32x32x16_bf16 v[160:175], v[52:55], v[104:107], v[160:175]
    ds_read_b128 v[80:83], v22 offset:16384
    ds_read_b128 v[84:87], v22 offset:20480
    v_fmac_f32 v57, s46, v59
    v_cvt_pk_bf16_f32 v48, v56, v57
    v_lshlrev_b32 v60, 16, v33
    v_mfma_f32_16x16x32_bf16 a[128:131], v[28:31], v[32:35], a[128:131]
    v_and_b32 v61, 0xffff0000, v33
    v_mfma_f32_32x32x16_bf16 a[148:163], v[32:35], v[32:35], a[148:163]
    ds_read_b128 v[88:91], v22 offset:24576
    ds_read_b128 v[92:95], v22 offset:28672
    v_lshlrev_b32 v62, 16, v37
    v_and_b32 v63, 0xffff0000, v37
    v_fmac_f32 v60, s46, v62
    v_mfma_f32_32x32x16_bf16 v[176:191], v[52:55], v[108:111], v[176:191]
    ds_read_b128 v[40:43], v19 offset:0
    ds_read_b128 v[44:47], v19 offset:16384
    v_fmac_f32 v61, s46, v63
    v_cvt_pk_bf16_f32 v49, v60, v61
    v_lshlrev_b32 v56, 16, v34
    v_mfma_f32_32x32x16_bf16 v[192:207], v[52:55], v[112:115], v[192:207]
    ds_read_b128 a[12:15], v19 offset:0
    ds_read_b128 a[76:79], v19 offset:16384
    v_and_b32 v57, 0xffff0000, v34
    v_lshlrev_b32 v58, 16, v38
    v_and_b32 v59, 0xffff0000, v38
    v_mfma_f32_32x32x16_bf16 v[208:223], v[52:55], v[116:119], v[208:223]
    v_fmac_f32 v56, s46, v58
    v_fmac_f32 v57, s46, v59
    v_cvt_pk_bf16_f32 v50, v56, v57
    v_lshlrev_b32 v60, 16, v35
    v_and_b32 v61, 0xffff0000, v35
    v_mfma_f32_16x16x32_bf16 a[128:131], v[28:31], v[36:39], a[128:131]
    v_lshlrev_b32 v62, 16, v39
    v_mfma_f32_32x32x16_bf16 a[148:163], v[36:39], v[36:39], a[148:163]
    v_and_b32 v63, 0xffff0000, v39
    v_fmac_f32 v60, s46, v62
    v_fmac_f32 v61, s46, v63
    v_cvt_pk_bf16_f32 v51, v60, v61
    v_mfma_f32_32x32x16_bf16 v[224:239], v[52:55], v[120:123], v[224:239]
    v_mfma_f32_32x32x16_bf16 v[240:255], v[52:55], v[124:127], v[240:255]
    s_waitcnt vmcnt(8) lgkmcnt(0)
    s_nop 1
    v_mfma_f32_32x32x16_bf16 v[128:143], v[48:51], v[64:67], v[128:143]
    s_add_u32 m0, s43, 0
    s_add_u32 s38, s41, s54
    buffer_load_dwordx4 v8, s[8:11], s38 offen lds
    ds_read_b128 v[96:99], v23 offset:0
    ds_read_b128 v[100:103], v23 offset:4096
    v_mfma_f32_32x32x16_bf16 v[144:159], v[48:51], v[68:71], v[144:159]
    ds_read_b128 v[104:107], v23 offset:8192
    ds_read_b128 v[108:111], v23 offset:12288
    v_lshlrev_b32 v56, 16, v40
    v_and_b32 v57, 0xffff0000, v40
    v_lshlrev_b32 v58, 16, v44
    v_mfma_f32_32x32x16_bf16 v[160:175], v[48:51], v[72:75], v[160:175]
    buffer_load_dwordx4 v9, s[8:11], s38 offen offset:1024 lds
    ds_read_b128 v[112:115], v23 offset:16384
    ds_read_b128 v[116:119], v23 offset:20480
    v_and_b32 v59, 0xffff0000, v44
    v_fmac_f32 v56, s46, v58
    v_mfma_f32_16x16x32_bf16 a[128:131], v[28:31], v[40:43], a[128:131]
    v_fmac_f32 v57, s46, v59
    v_mfma_f32_32x32x16_bf16 a[148:163], v[40:43], v[40:43], a[148:163]
    buffer_load_dwordx4 v10, s[8:11], s38 offen offset:2048 lds
    ds_read_b128 v[120:123], v23 offset:24576
    ds_read_b128 v[124:127], v23 offset:28672
    v_cvt_pk_bf16_f32 v52, v56, v57
    v_lshlrev_b32 v60, 16, v41
    v_mfma_f32_32x32x16_bf16 v[176:191], v[48:51], v[76:79], v[176:191]
    ds_read_b128 v[32:35], v16 offset:32768
    ds_read_b128 v[36:39], v16 offset:49152
    v_and_b32 v61, 0xffff0000, v41
    v_lshlrev_b32 v62, 16, v45
    v_and_b32 v63, 0xffff0000, v45
    v_mfma_f32_32x32x16_bf16 v[192:207], v[48:51], v[80:83], v[192:207]
    buffer_load_dwordx4 v11, s[8:11], s38 offen offset:3072 lds
    ds_read_b128 a[16:19], v16 offset:32768
    ds_read_b128 a[80:83], v16 offset:49152
    v_fmac_f32 v60, s46, v62
    v_fmac_f32 v61, s46, v63
    v_mfma_f32_32x32x16_bf16 v[208:223], v[48:51], v[84:87], v[208:223]
    v_cvt_pk_bf16_f32 v53, v60, v61
    v_lshlrev_b32 v56, 16, v42
    v_and_b32 v57, 0xffff0000, v42
    v_lshlrev_b32 v58, 16, v46
    v_and_b32 v59, 0xffff0000, v46
    v_mfma_f32_16x16x32_bf16 a[128:131], v[28:31], v[44:47], a[128:131]
    v_fmac_f32 v56, s46, v58
    v_mfma_f32_32x32x16_bf16 a[148:163], v[44:47], v[44:47], a[148:163]
    s_add_u32 m0, s43, 16384
    s_add_u32 s38, s45, s54
    buffer_load_dwordx4 v8, s[8:11], s38 offen lds
    v_fmac_f32 v57, s46, v59
    v_cvt_pk_bf16_f32 v54, v56, v57
    v_mfma_f32_32x32x16_bf16 v[224:239], v[48:51], v[88:91], v[224:239]
    buffer_load_dwordx4 v9, s[8:11], s38 offen offset:1024 lds
    v_lshlrev_b32 v60, 16, v43
    v_and_b32 v61, 0xffff0000, v43
    v_lshlrev_b32 v62, 16, v47
    v_and_b32 v63, 0xffff0000, v47
    v_mfma_f32_32x32x16_bf16 v[240:255], v[48:51], v[92:95], v[240:255]
    v_fmac_f32 v60, s46, v62
    v_fmac_f32 v61, s46, v63
    v_cvt_pk_bf16_f32 v55, v60, v61
    s_waitcnt lgkmcnt(0)
    s_nop 1
    v_mfma_f32_32x32x16_bf16 v[128:143], v[52:55], v[96:99], v[128:143]
    buffer_load_dwordx4 v10, s[8:11], s38 offen offset:2048 lds
    v_lshlrev_b32 v56, 16, v32
    v_and_b32 v57, 0xffff0000, v32
    s_waitcnt vmcnt(7)
    s_barrier
    v_mfma_f32_32x32x16_bf16 v[144:159], v[52:55], v[100:103], v[144:159]
    ds_read_b128 v[64:67], v20 offset:32768
    ds_read_b128 v[68:71], v20 offset:36864
    v_lshlrev_b32 v58, 16, v36
    v_and_b32 v59, 0xffff0000, v36
    v_fmac_f32 v56, s46, v58
    v_mfma_f32_32x32x16_bf16 v[160:175], v[52:55], v[104:107], v[160:175]
    buffer_load_dwordx4 v11, s[8:11], s38 offen offset:3072 lds
    ds_read_b128 v[72:75], v20 offset:40960
    ds_read_b128 v[76:79], v20 offset:45056
    v_fmac_f32 v57, s46, v59
    v_cvt_pk_bf16_f32 v48, v56, v57
    v_mfma_f32_16x16x32_bf16 a[128:131], v[28:31], v[32:35], a[128:131]
    v_lshlrev_b32 v60, 16, v33
    v_mfma_f32_32x32x16_bf16 a[148:163], v[32:35], v[32:35], a[148:163]
    ds_read_b128 v[80:83], v20 offset:49152
    ds_read_b128 v[84:87], v20 offset:53248
    v_and_b32 v61, 0xffff0000, v33
    v_lshlrev_b32 v62, 16, v37
    v_and_b32 v63, 0xffff0000, v37
    v_mfma_f32_32x32x16_bf16 v[176:191], v[52:55], v[108:111], v[176:191]
    s_add_u32 m0, s44, 65536
    s_nop 0
    buffer_load_dwordx4 v12, s[24:27], s54 offen lds
    ds_read_b128 v[88:91], v20 offset:57344
    ds_read_b128 v[92:95], v20 offset:61440
    v_mfma_f32_32x32x16_bf16 v[192:207], v[52:55], v[112:115], v[192:207]
    ds_read_b128 v[40:43], v17 offset:32768
    ds_read_b128 v[44:47], v17 offset:49152
    v_fmac_f32 v60, s46, v62
    v_fmac_f32 v61, s46, v63
    v_cvt_pk_bf16_f32 v49, v60, v61
    v_mfma_f32_32x32x16_bf16 v[208:223], v[52:55], v[116:119], v[208:223]
    buffer_load_dwordx4 v13, s[24:27], s54 offen offset:1024 lds
    ds_read_b128 a[20:23], v17 offset:32768
    ds_read_b128 a[84:87], v17 offset:49152
    v_lshlrev_b32 v56, 16, v34
    v_and_b32 v57, 0xffff0000, v34
    v_mfma_f32_16x16x32_bf16 a[128:131], v[28:31], v[36:39], a[128:131]
    v_lshlrev_b32 v58, 16, v38
    v_mfma_f32_32x32x16_bf16 a[148:163], v[36:39], v[36:39], a[148:163]
    buffer_load_dwordx4 v14, s[24:27], s54 offen offset:2048 lds
    v_and_b32 v59, 0xffff0000, v38
    v_fmac_f32 v56, s46, v58
    v_fmac_f32 v57, s46, v59
    v_cvt_pk_bf16_f32 v50, v56, v57
    v_mfma_f32_32x32x16_bf16 v[224:239], v[52:55], v[120:123], v[224:239]
    v_lshlrev_b32 v60, 16, v35
    v_and_b32 v61, 0xffff0000, v35
    v_lshlrev_b32 v62, 16, v39
    v_and_b32 v63, 0xffff0000, v39
    v_fmac_f32 v60, s46, v62
    v_mfma_f32_32x32x16_bf16 v[240:255], v[52:55], v[124:127], v[240:255]
    v_fmac_f32 v61, s46, v63
    v_cvt_pk_bf16_f32 v51, v60, v61
    s_waitcnt lgkmcnt(0)
    s_nop 1
    v_mfma_f32_32x32x16_bf16 v[128:143], v[48:51], v[64:67], v[128:143]
    buffer_load_dwordx4 v15, s[24:27], s54 offen offset:3072 lds
    v_readfirstlane_b32 s95, v6
    s_nop 0
    s_add_u32 s95, s95, 1
    ds_read_b128 v[96:99], v21 offset:32768
    v_mfma_f32_32x32x16_bf16 v[144:159], v[48:51], v[68:71], v[144:159]
    ds_read_b128 v[100:103], v21 offset:36864
    ds_read_b128 v[104:107], v21 offset:40960
    ds_read_b128 v[108:111], v21 offset:45056
    v_lshlrev_b32 v56, 16, v40
    v_and_b32 v57, 0xffff0000, v40
    v_mfma_f32_32x32x16_bf16 v[160:175], v[48:51], v[72:75], v[160:175]
    s_add_u32 m0, s44, 69632
    s_nop 0
    buffer_load_dwordx4 v12, s[28:31], s54 offen lds
    ds_read_b128 v[112:115], v21 offset:49152
    ds_read_b128 v[116:119], v21 offset:53248
    v_mfma_f32_16x16x32_bf16 a[128:131], v[28:31], v[40:43], a[128:131]
    v_lshlrev_b32 v58, 16, v44
    v_mfma_f32_32x32x16_bf16 a[148:163], v[40:43], v[40:43], a[148:163]
    buffer_load_dwordx4 v13, s[28:31], s54 offen offset:1024 lds
    ds_read_b128 v[120:123], v21 offset:57344
    ds_read_b128 v[124:127], v21 offset:61440
    v_and_b32 v59, 0xffff0000, v44
    v_fmac_f32 v56, s46, v58
    v_mfma_f32_32x32x16_bf16 v[176:191], v[48:51], v[76:79], v[176:191]
    ds_read_b128 v[32:35], v18 offset:32768
    ds_read_b128 v[36:39], v18 offset:49152
    v_fmac_f32 v57, s46, v59
    v_cvt_pk_bf16_f32 v52, v56, v57
    v_lshlrev_b32 v60, 16, v41
    v_mfma_f32_32x32x16_bf16 v[192:207], v[48:51], v[80:83], v[192:207]
    ds_read_b128 a[24:27], v18 offset:32768
    ds_read_b128 a[88:91], v18 offset:49152
    v_and_b32 v61, 0xffff0000, v41
    v_lshlrev_b32 v62, 16, v45
    v_and_b32 v63, 0xffff0000, v45
    v_mfma_f32_32x32x16_bf16 v[208:223], v[48:51], v[84:87], v[208:223]
    buffer_load_dwordx4 v14, s[28:31], s54 offen offset:2048 lds
    v_fmac_f32 v60, s46, v62
    v_fmac_f32 v61, s46, v63
    v_cvt_pk_bf16_f32 v53, v60, v61
    v_lshlrev_b32 v56, 16, v42
    v_mfma_f32_16x16x32_bf16 a[128:131], v[28:31], v[44:47], a[128:131]
    v_and_b32 v57, 0xffff0000, v42
    v_mfma_f32_32x32x16_bf16 a[148:163], v[44:47], v[44:47], a[148:163]
    buffer_load_dwordx4 v15, s[28:31], s54 offen offset:3072 lds
    v_lshlrev_b32 v58, 16, v46
    v_and_b32 v59, 0xffff0000, v46
    v_fmac_f32 v56, s46, v58
    v_fmac_f32 v57, s46, v59
    v_mfma_f32_32x32x16_bf16 v[224:239], v[48:51], v[88:91], v[224:239]
    v_cvt_pk_bf16_f32 v54, v56, v57
    v_lshlrev_b32 v60, 16, v43
    v_and_b32 v61, 0xffff0000, v43
    v_lshlrev_b32 v62, 16, v47
    v_and_b32 v63, 0xffff0000, v47
    v_mfma_f32_32x32x16_bf16 v[240:255], v[48:51], v[92:95], v[240:255]
    v_fmac_f32 v60, s46, v62
    v_fmac_f32 v61, s46, v63
    v_cvt_pk_bf16_f32 v55, v60, v61
    s_waitcnt lgkmcnt(0)
    s_nop 1
    v_mfma_f32_32x32x16_bf16 v[128:143], v[52:55], v[96:99], v[128:143]
    ds_read_b128 v[64:67], v22 offset:32768
    ds_read_b128 v[68:71], v22 offset:36864
    v_lshlrev_b32 v56, 16, v32
    v_and_b32 v57, 0xffff0000, v32
    v_lshlrev_b32 v58, 16, v36
    v_mfma_f32_32x32x16_bf16 v[144:159], v[52:55], v[100:103], v[144:159]
    ds_read_b128 v[72:75], v22 offset:40960
    ds_read_b128 v[76:79], v22 offset:45056
    v_and_b32 v59, 0xffff0000, v36
    v_fmac_f32 v56, s46, v58
    v_fmac_f32 v57, s46, v59
    v_mfma_f32_32x32x16_bf16 v[160:175], v[52:55], v[104:107], v[160:175]
    ds_read_b128 v[80:83], v22 offset:49152
    ds_read_b128 v[84:87], v22 offset:53248
    v_cvt_pk_bf16_f32 v48, v56, v57
    v_lshlrev_b32 v60, 16, v33
    v_and_b32 v61, 0xffff0000, v33
    v_mfma_f32_16x16x32_bf16 a[128:131], v[28:31], v[32:35], a[128:131]
    v_lshlrev_b32 v62, 16, v37
    v_mfma_f32_32x32x16_bf16 a[148:163], v[32:35], v[32:35], a[148:163]
    ds_read_b128 v[88:91], v22 offset:57344
    ds_read_b128 v[92:95], v22 offset:61440
    v_and_b32 v63, 0xffff0000, v37
    v_fmac_f32 v60, s46, v62
    v_fmac_f32 v61, s46, v63
    v_mfma_f32_32x32x16_bf16 v[176:191], v[52:55], v[108:111], v[176:191]
    ds_read_b128 v[40:43], v19 offset:32768
    ds_read_b128 v[44:47], v19 offset:49152
    v_cvt_pk_bf16_f32 v49, v60, v61
    v_lshlrev_b32 v56, 16, v34
    v_and_b32 v57, 0xffff0000, v34
    v_mfma_f32_32x32x16_bf16 v[192:207], v[52:55], v[112:115], v[192:207]
    ds_read_b128 a[28:31], v19 offset:32768
    ds_read_b128 a[92:95], v19 offset:49152
    v_lshlrev_b32 v58, 16, v38
    v_and_b32 v59, 0xffff0000, v38
    v_fmac_f32 v56, s46, v58
    v_mfma_f32_32x32x16_bf16 v[208:223], v[52:55], v[116:119], v[208:223]
    v_fmac_f32 v57, s46, v59
    v_cvt_pk_bf16_f32 v50, v56, v57
    v_lshlrev_b32 v60, 16, v35
    v_and_b32 v61, 0xffff0000, v35
    v_lshlrev_b32 v62, 16, v39
    v_mfma_f32_16x16x32_bf16 a[128:131], v[28:31], v[36:39], a[128:131]
    v_and_b32 v63, 0xffff0000, v39
    v_mfma_f32_32x32x16_bf16 a[148:163], v[36:39], v[36:39], a[148:163]
    v_fmac_f32 v60, s46, v62
    v_fmac_f32 v61, s46, v63
    v_cvt_pk_bf16_f32 v51, v60, v61
    v_mfma_f32_32x32x16_bf16 v[224:239], v[52:55], v[120:123], v[224:239]
    v_mfma_f32_32x32x16_bf16 v[240:255], v[52:55], v[124:127], v[240:255]
    s_waitcnt vmcnt(8) lgkmcnt(0)
    s_nop 1
    v_mfma_f32_32x32x16_bf16 v[128:143], v[48:51], v[64:67], v[128:143]
    s_add_u32 m0, s43, 32768
    s_add_u32 s38, s41, s55
    buffer_load_dwordx4 v8, s[8:11], s38 offen lds
    ds_read_b128 v[96:99], v23 offset:32768
    ds_read_b128 v[100:103], v23 offset:36864
    v_mfma_f32_32x32x16_bf16 v[144:159], v[48:51], v[68:71], v[144:159]
    ds_read_b128 v[104:107], v23 offset:40960
    ds_read_b128 v[108:111], v23 offset:45056
    v_lshlrev_b32 v56, 16, v40
    v_and_b32 v57, 0xffff0000, v40
    v_lshlrev_b32 v58, 16, v44
    v_mfma_f32_32x32x16_bf16 v[160:175], v[48:51], v[72:75], v[160:175]
    buffer_load_dwordx4 v9, s[8:11], s38 offen offset:1024 lds
    ds_read_b128 v[112:115], v23 offset:49152
    ds_read_b128 v[116:119], v23 offset:53248
    v_and_b32 v59, 0xffff0000, v44
    v_fmac_f32 v56, s46, v58
    v_mfma_f32_16x16x32_bf16 a[128:131], v[28:31], v[40:43], a[128:131]
    v_fmac_f32 v57, s46, v59
    v_mfma_f32_32x32x16_bf16 a[148:163], v[40:43], v[40:43], a[148:163]
    buffer_load_dwordx4 v10, s[8:11], s38 offen offset:2048 lds
    ds_read_b128 v[120:123], v23 offset:57344
    ds_read_b128 v[124:127], v23 offset:61440
    v_cvt_pk_bf16_f32 v52, v56, v57
    v_lshlrev_b32 v60, 16, v41
    v_mfma_f32_32x32x16_bf16 v[176:191], v[48:51], v[76:79], v[176:191]
    ds_read_b128 v[32:35], v16 offset:0
    ds_read_b128 v[36:39], v16 offset:16384
    v_and_b32 v61, 0xffff0000, v41
    v_lshlrev_b32 v62, 16, v45
    v_and_b32 v63, 0xffff0000, v45
    v_mfma_f32_32x32x16_bf16 v[192:207], v[48:51], v[80:83], v[192:207]
    buffer_load_dwordx4 v11, s[8:11], s38 offen offset:3072 lds
    ds_read_b128 a[32:35], v16 offset:0
    ds_read_b128 a[96:99], v16 offset:16384
    v_fmac_f32 v60, s46, v62
    v_fmac_f32 v61, s46, v63
    v_mfma_f32_32x32x16_bf16 v[208:223], v[48:51], v[84:87], v[208:223]
    v_cvt_pk_bf16_f32 v53, v60, v61
    v_lshlrev_b32 v56, 16, v42
    v_and_b32 v57, 0xffff0000, v42
    v_lshlrev_b32 v58, 16, v46
    v_and_b32 v59, 0xffff0000, v46
    v_mfma_f32_16x16x32_bf16 a[128:131], v[28:31], v[44:47], a[128:131]
    v_fmac_f32 v56, s46, v58
    v_mfma_f32_32x32x16_bf16 a[148:163], v[44:47], v[44:47], a[148:163]
    s_add_u32 m0, s43, 49152
    s_add_u32 s38, s45, s55
    buffer_load_dwordx4 v8, s[8:11], s38 offen lds
    v_fmac_f32 v57, s46, v59
    v_cvt_pk_bf16_f32 v54, v56, v57
    v_mfma_f32_32x32x16_bf16 v[224:239], v[48:51], v[88:91], v[224:239]
    buffer_load_dwordx4 v9, s[8:11], s38 offen offset:1024 lds
    v_lshlrev_b32 v60, 16, v43
    v_and_b32 v61, 0xffff0000, v43
    v_lshlrev_b32 v62, 16, v47
    v_and_b32 v63, 0xffff0000, v47
    v_mfma_f32_32x32x16_bf16 v[240:255], v[48:51], v[92:95], v[240:255]
    v_fmac_f32 v60, s46, v62
    v_fmac_f32 v61, s46, v63
    v_cvt_pk_bf16_f32 v55, v60, v61
    s_waitcnt lgkmcnt(0)
    s_nop 1
    v_mfma_f32_32x32x16_bf16 v[128:143], v[52:55], v[96:99], v[128:143]
    buffer_load_dwordx4 v10, s[8:11], s38 offen offset:2048 lds
    v_add_u32 v20, 65536, v20
    v_add_u32 v21, 65536, v21
    s_waitcnt vmcnt(7)
    s_barrier
    v_mfma_f32_32x32x16_bf16 v[144:159], v[52:55], v[100:103], v[144:159]
    v_add_u32 v22, 65536, v22
    v_add_u32 v23, 65536, v23
    ds_read_b128 v[64:67], v20 offset:0
    ds_read_b128 v[68:71], v20 offset:4096
    v_lshlrev_b32 v56, 16, v32
    v_mfma_f32_32x32x16_bf16 v[160:175], v[52:55], v[104:107], v[160:175]
    buffer_load_dwordx4 v11, s[8:11], s38 offen offset:3072 lds
    ds_read_b128 v[72:75], v20 offset:8192
    ds_read_b128 v[76:79], v20 offset:12288
    v_and_b32 v57, 0xffff0000, v32
    v_lshlrev_b32 v58, 16, v36
    v_mfma_f32_16x16x32_bf16 a[128:131], v[28:31], v[32:35], a[128:131]
    v_and_b32 v59, 0xffff0000, v36
    v_mfma_f32_32x32x16_bf16 a[148:163], v[32:35], v[32:35], a[148:163]
    ds_read_b128 v[80:83], v20 offset:16384
    ds_read_b128 v[84:87], v20 offset:20480
    v_fmac_f32 v56, s46, v58
    v_fmac_f32 v57, s46, v59
    v_cvt_pk_bf16_f32 v48, v56, v57
    v_mfma_f32_32x32x16_bf16 v[176:191], v[52:55], v[108:111], v[176:191]
    s_add_u32 m0, s44, 0
    s_nop 0
    buffer_load_dwordx4 v12, s[24:27], s55 offen lds
    ds_read_b128 v[88:91], v20 offset:24576
    ds_read_b128 v[92:95], v20 offset:28672
    v_mfma_f32_32x32x16_bf16 v[192:207], v[52:55], v[112:115], v[192:207]
    ds_read_b128 v[40:43], v17 offset:0
    ds_read_b128 v[44:47], v17 offset:16384
    v_lshlrev_b32 v60, 16, v33
    v_and_b32 v61, 0xffff0000, v33
    v_lshlrev_b32 v62, 16, v37
    v_mfma_f32_32x32x16_bf16 v[208:223], v[52:55], v[116:119], v[208:223]
    buffer_load_dwordx4 v13, s[24:27], s55 offen offset:1024 lds
    ds_read_b128 a[36:39], v17 offset:0
    ds_read_b128 a[100:103], v17 offset:16384
    v_and_b32 v63, 0xffff0000, v37
    v_fmac_f32 v60, s46, v62
    v_mfma_f32_16x16x32_bf16 a[128:131], v[28:31], v[36:39], a[128:131]
    v_fmac_f32 v61, s46, v63
    v_mfma_f32_32x32x16_bf16 a[148:163], v[36:39], v[36:39], a[148:163]
    buffer_load_dwordx4 v14, s[24:27], s55 offen offset:2048 lds
    v_cvt_pk_bf16_f32 v49, v60, v61
    v_lshlrev_b32 v56, 16, v34
    v_and_b32 v57, 0xffff0000, v34
    v_lshlrev_b32 v58, 16, v38
    v_mfma_f32_32x32x16_bf16 v[224:239], v[52:55], v[120:123], v[224:239]
    v_and_b32 v59, 0xffff0000, v38
    v_fmac_f32 v56, s46, v58
    v_fmac_f32 v57, s46, v59
    v_cvt_pk_bf16_f32 v50, v56, v57
    v_lshlrev_b32 v60, 16, v35
    v_mfma_f32_32x32x16_bf16 v[240:255], v[52:55], v[124:127], v[240:255]
    v_and_b32 v61, 0xffff0000, v35
    v_lshlrev_b32 v62, 16, v39
    v_and_b32 v63, 0xffff0000, v39
    v_fmac_f32 v60, s46, v62
    v_fmac_f32 v61, s46, v63
    v_cvt_pk_bf16_f32 v51, v60, v61
    s_waitcnt lgkmcnt(0)
    s_nop 1
    v_mfma_f32_32x32x16_bf16 v[128:143], v[48:51], v[64:67], v[128:143]
    buffer_load_dwordx4 v15, s[24:27], s55 offen offset:3072 lds
    ds_read_b128 v[96:99], v21 offset:0
    ds_read_b128 v[100:103], v21 offset:4096
    v_lshlrev_b32 v56, 16, v40
    v_and_b32 v57, 0xffff0000, v40
    v_mfma_f32_32x32x16_bf16 v[144:159], v[48:51], v[68:71], v[144:159]
    ds_read_b128 v[104:107], v21 offset:8192
    ds_read_b128 v[108:111], v21 offset:12288
    v_lshlrev_b32 v58, 16, v44
    v_and_b32 v59, 0xffff0000, v44
    v_fmac_f32 v56, s46, v58
    v_mfma_f32_32x32x16_bf16 v[160:175], v[48:51], v[72:75], v[160:175]
    s_add_u32 m0, s44, 4096
    s_nop 0
    buffer_load_dwordx4 v12, s[28:31], s55 offen lds
    ds_read_b128 v[112:115], v21 offset:16384
    ds_read_b128 v[116:119], v21 offset:20480
    v_mfma_f32_16x16x32_bf16 a[128:131], v[28:31], v[40:43], a[128:131]
    v_fmac_f32 v57, s46, v59
    v_mfma_f32_32x32x16_bf16 a[148:163], v[40:43], v[40:43], a[148:163]
    buffer_load_dwordx4 v13, s[28:31], s55 offen offset:1024 lds
    ds_read_b128 v[120:123], v21 offset:24576
    ds_read_b128 v[124:127], v21 offset:28672
    v_cvt_pk_bf16_f32 v52, v56, v57
    v_lshlrev_b32 v60, 16, v41
    v_mfma_f32_32x32x16_bf16 v[176:191], v[48:51], v[76:79], v[176:191]
    ds_read_b128 v[32:35], v18 offset:0
    ds_read_b128 v[36:39], v18 offset:16384
    v_and_b32 v61, 0xffff0000, v41
    v_lshlrev_b32 v62, 16, v45
    v_and_b32 v63, 0xffff0000, v45
    v_mfma_f32_32x32x16_bf16 v[192:207], v[48:51], v[80:83], v[192:207]
    ds_read_b128 a[40:43], v18 offset:0
    ds_read_b128 a[104:107], v18 offset:16384
    v_fmac_f32 v60, s46, v62
    v_fmac_f32 v61, s46, v63
    v_cvt_pk_bf16_f32 v53, v60, v61
    v_mfma_f32_32x32x16_bf16 v[208:223], v[48:51], v[84:87], v[208:223]
    buffer_load_dwordx4 v14, s[28:31], s55 offen offset:2048 lds
    v_lshlrev_b32 v56, 16, v42
    v_and_b32 v57, 0xffff0000, v42
    v_lshlrev_b32 v58, 16, v46
    v_and_b32 v59, 0xffff0000, v46
    v_mfma_f32_16x16x32_bf16 a[128:131], v[28:31], v[44:47], a[128:131]
    v_fmac_f32 v56, s46, v58
    v_mfma_f32_32x32x16_bf16 a[148:163], v[44:47], v[44:47], a[148:163]
    buffer_load_dwordx4 v15, s[28:31], s55 offen offset:3072 lds
    v_fmac_f32 v57, s46, v59
    v_cvt_pk_bf16_f32 v54, v56, v57
    v_lshlrev_b32 v60, 16, v43
    v_and_b32 v61, 0xffff0000, v43
    v_mfma_f32_32x32x16_bf16 v[224:239], v[48:51], v[88:91], v[224:239]
    v_lshlrev_b32 v62, 16, v47
    v_and_b32 v63, 0xffff0000, v47
    v_fmac_f32 v60, s46, v62
    v_fmac_f32 v61, s46, v63
    v_cvt_pk_bf16_f32 v55, v60, v61
    v_mfma_f32_32x32x16_bf16 v[240:255], v[48:51], v[92:95], v[240:255]
    s_waitcnt lgkmcnt(0)
    s_nop 1
    v_mfma_f32_32x32x16_bf16 v[128:143], v[52:55], v[96:99], v[128:143]
    ds_read_b128 v[64:67], v22 offset:0
    ds_read_b128 v[68:71], v22 offset:4096
    v_lshlrev_b32 v56, 16, v32
    v_and_b32 v57, 0xffff0000, v32
    v_lshlrev_b32 v58, 16, v36
    v_mfma_f32_32x32x16_bf16 v[144:159], v[52:55], v[100:103], v[144:159]
    s_lshl_b32 s42, s52, 3
    s_add_u32 m0, s49, s42
    s_mul_i32 s38, s52, 688
    s_add_u32 s38, s38, s48
    buffer_load_dwordx4 v26, s[12:15], s38 offen lds
    v_mfma_f32_32x32x16_bf16 v[160:175], v[52:55], v[104:107], v[160:175]
    ds_read_b128 v[72:75], v22 offset:8192
    ds_read_b128 v[76:79], v22 offset:12288
    ds_read_b128 v[80:83], v22 offset:16384
    ds_read_b128 v[84:87], v22 offset:20480
    v_and_b32 v59, 0xffff0000, v36
    v_mfma_f32_16x16x32_bf16 a[128:131], v[28:31], v[32:35], a[128:131]
    v_fmac_f32 v56, s46, v58
    v_mfma_f32_32x32x16_bf16 a[148:163], v[32:35], v[32:35], a[148:163]
    ds_read_b128 v[88:91], v22 offset:24576
    ds_read_b128 v[92:95], v22 offset:28672
    v_fmac_f32 v57, s46, v59
    v_cvt_pk_bf16_f32 v48, v56, v57
    v_lshlrev_b32 v60, 16, v33
    v_mfma_f32_32x32x16_bf16 v[176:191], v[52:55], v[108:111], v[176:191]
    ds_read_b128 v[40:43], v19 offset:0
    ds_read_b128 v[44:47], v19 offset:16384
    v_and_b32 v61, 0xffff0000, v33
    v_lshlrev_b32 v62, 16, v37
    v_and_b32 v63, 0xffff0000, v37
    v_mfma_f32_32x32x16_bf16 v[192:207], v[52:55], v[112:115], v[192:207]
    ds_read_b128 a[44:47], v19 offset:0
    ds_read_b128 a[108:111], v19 offset:16384
    v_fmac_f32 v60, s46, v62
    v_fmac_f32 v61, s46, v63
    v_cvt_pk_bf16_f32 v49, v60, v61
    v_mfma_f32_32x32x16_bf16 v[208:223], v[52:55], v[116:119], v[208:223]
    v_lshlrev_b32 v56, 16, v34
    v_and_b32 v57, 0xffff0000, v34
    v_lshlrev_b32 v58, 16, v38
    v_and_b32 v59, 0xffff0000, v38
    v_fmac_f32 v56, s46, v58
    v_mfma_f32_16x16x32_bf16 a[128:131], v[28:31], v[36:39], a[128:131]
    v_fmac_f32 v57, s46, v59
    v_mfma_f32_32x32x16_bf16 a[148:163], v[36:39], v[36:39], a[148:163]
    s_add_u32 m0, m0, 16384
    s_nop 0
    buffer_load_dwordx4 v27, s[16:19], s38 offen lds
    v_cvt_pk_bf16_f32 v50, v56, v57
    v_lshlrev_b32 v60, 16, v35
    v_mfma_f32_32x32x16_bf16 v[224:239], v[52:55], v[120:123], v[224:239]
    v_and_b32 v61, 0xffff0000, v35
    v_lshlrev_b32 v62, 16, v39
    v_and_b32 v63, 0xffff0000, v39
    v_fmac_f32 v60, s46, v62
    v_fmac_f32 v61, s46, v63
    v_mfma_f32_32x32x16_bf16 v[240:255], v[52:55], v[124:127], v[240:255]
    v_cvt_pk_bf16_f32 v51, v60, v61
    v_and_b32 v4, 7, v1
    v_lshrrev_b32 v5, 2, v1
    s_waitcnt vmcnt(10) lgkmcnt(0)
    s_nop 1
    v_mfma_f32_32x32x16_bf16 v[128:143], v[48:51], v[64:67], v[128:143]
    ds_read_b128 v[96:99], v23 offset:0
    ds_read_b128 v[100:103], v23 offset:4096
    v_lshlrev_b32 v56, 16, v40
    v_and_b32 v57, 0xffff0000, v40
    v_lshlrev_b32 v58, 16, v44
    v_mfma_f32_32x32x16_bf16 v[144:159], v[48:51], v[68:71], v[144:159]
    ds_read_b128 v[104:107], v23 offset:8192
    ds_read_b128 v[108:111], v23 offset:12288
    v_and_b32 v59, 0xffff0000, v44
    v_fmac_f32 v56, s46, v58
    v_fmac_f32 v57, s46, v59
    v_mfma_f32_32x32x16_bf16 v[160:175], v[48:51], v[72:75], v[160:175]
    ds_read_b128 v[112:115], v23 offset:16384
    ds_read_b128 v[116:119], v23 offset:20480
    v_cvt_pk_bf16_f32 v52, v56, v57
    v_lshlrev_b32 v60, 16, v41
    v_and_b32 v61, 0xffff0000, v41
    v_mfma_f32_16x16x32_bf16 a[128:131], v[28:31], v[40:43], a[128:131]
    v_lshlrev_b32 v62, 16, v45
    v_mfma_f32_32x32x16_bf16 a[148:163], v[40:43], v[40:43], a[148:163]
    ds_read_b128 v[120:123], v23 offset:24576
    ds_read_b128 v[124:127], v23 offset:28672
    v_and_b32 v63, 0xffff0000, v45
    v_fmac_f32 v60, s46, v62
    v_fmac_f32 v61, s46, v63
    v_mfma_f32_32x32x16_bf16 v[176:191], v[48:51], v[76:79], v[176:191]
    ds_read_b128 v[32:35], v16 offset:32768
    ds_read_b128 v[36:39], v16 offset:49152
    v_cvt_pk_bf16_f32 v53, v60, v61
    v_lshlrev_b32 v56, 16, v42
    v_and_b32 v57, 0xffff0000, v42
    v_mfma_f32_32x32x16_bf16 v[192:207], v[48:51], v[80:83], v[192:207]
    s_lshl_b32 s42, s53, 3
    s_add_u32 m0, s49, s42
    s_mul_i32 s38, s53, 688
    s_add_u32 s38, s38, s48
    buffer_load_dwordx4 v26, s[12:15], s38 offen lds
    v_mfma_f32_32x32x16_bf16 v[208:223], v[48:51], v[84:87], v[208:223]
    ds_read_b128 a[48:51], v16 offset:32768
    ds_read_b128 a[112:115], v16 offset:49152
    v_lshlrev_b32 v58, 16, v46
    v_and_b32 v59, 0xffff0000, v46
    v_fmac_f32 v56, s46, v58
    v_mfma_f32_16x16x32_bf16 a[128:131], v[28:31], v[44:47], a[128:131]
    v_fmac_f32 v57, s46, v59
    v_mfma_f32_32x32x16_bf16 a[148:163], v[44:47], v[44:47], a[148:163]
    v_cvt_pk_bf16_f32 v54, v56, v57
    v_lshlrev_b32 v60, 16, v43
    v_and_b32 v61, 0xffff0000, v43
    v_lshlrev_b32 v62, 16, v47
    v_and_b32 v63, 0xffff0000, v47
    v_mfma_f32_32x32x16_bf16 v[224:239], v[48:51], v[88:91], v[224:239]
    v_fmac_f32 v60, s46, v62
    v_fmac_f32 v61, s46, v63
    v_cvt_pk_bf16_f32 v55, v60, v61
    v_and_b32 v5, 4, v5
    v_xor_b32 v4, v4, v5
    v_mfma_f32_32x32x16_bf16 v[240:255], v[48:51], v[92:95], v[240:255]
    v_lshlrev_b32 v4, 4, v4
    v_lshrrev_b32 v5, 3, v1
    v_lshl_add_u32 v8, v5, 10, v4
    s_waitcnt lgkmcnt(0)
    s_nop 1
    v_mfma_f32_32x32x16_bf16 v[128:143], v[52:55], v[96:99], v[128:143]
    v_add_u32 v20, 4294901760, v20
    v_add_u32 v21, 4294901760, v21
    v_add_u32 v22, 4294901760, v22
    s_waitcnt vmcnt(3)
    s_barrier
    v_mfma_f32_32x32x16_bf16 v[144:159], v[52:55], v[100:103], v[144:159]
    v_add_u32 v23, 4294901760, v23
    ds_read_b128 v[64:67], v20 offset:0
    ds_read_b128 v[68:71], v20 offset:4096
    v_lshlrev_b32 v56, 16, v32
    v_and_b32 v57, 0xffff0000, v32
    v_mfma_f32_32x32x16_bf16 v[160:175], v[52:55], v[104:107], v[160:175]
    ds_read_b128 v[72:75], v20 offset:8192
    ds_read_b128 v[76:79], v20 offset:12288
    v_lshlrev_b32 v58, 16, v36
    v_and_b32 v59, 0xffff0000, v36
    v_fmac_f32 v56, s46, v58
    v_mfma_f32_16x16x32_bf16 a[128:131], v[28:31], v[32:35], a[128:131]
    v_fmac_f32 v57, s46, v59
    v_mfma_f32_32x32x16_bf16 a[148:163], v[32:35], v[32:35], a[148:163]
    s_add_u32 m0, m0, 16384
    s_nop 0
    buffer_load_dwordx4 v27, s[16:19], s38 offen lds
    ds_read_b128 v[80:83], v20 offset:16384
    ds_read_b128 v[84:87], v20 offset:20480
    v_mfma_f32_32x32x16_bf16 v[176:191], v[52:55], v[108:111], v[176:191]
    ds_read_b128 v[88:91], v20 offset:24576
    ds_read_b128 v[92:95], v20 offset:28672
    v_cvt_pk_bf16_f32 v48, v56, v57
    v_lshlrev_b32 v60, 16, v33
    v_and_b32 v61, 0xffff0000, v33
    v_mfma_f32_32x32x16_bf16 v[192:207], v[52:55], v[112:115], v[192:207]
    ds_read_b128 v[40:43], v17 offset:32768
    ds_read_b128 v[44:47], v17 offset:49152
    v_lshlrev_b32 v62, 16, v37
    v_and_b32 v63, 0xffff0000, v37
    v_fmac_f32 v60, s46, v62
    v_mfma_f32_32x32x16_bf16 v[208:223], v[52:55], v[116:119], v[208:223]
    ds_read_b128 a[52:55], v17 offset:32768
    ds_read_b128 a[116:119], v17 offset:49152
    v_fmac_f32 v61, s46, v63
    v_cvt_pk_bf16_f32 v49, v60, v61
    v_lshlrev_b32 v56, 16, v34
    v_mfma_f32_16x16x32_bf16 a[128:131], v[28:31], v[36:39], a[128:131]
    v_and_b32 v57, 0xffff0000, v34
    v_mfma_f32_32x32x16_bf16 a[148:163], v[36:39], v[36:39], a[148:163]
    v_lshlrev_b32 v58, 16, v38
    v_and_b32 v59, 0xffff0000, v38
    v_fmac_f32 v56, s46, v58
    v_fmac_f32 v57, s46, v59
    v_cvt_pk_bf16_f32 v50, v56, v57
    v_mfma_f32_32x32x16_bf16 v[224:239], v[52:55], v[120:123], v[224:239]
    v_lshlrev_b32 v60, 16, v35
    v_and_b32 v61, 0xffff0000, v35
    v_lshlrev_b32 v62, 16, v39
    v_and_b32 v63, 0xffff0000, v39
    v_fmac_f32 v60, s46, v62
    v_mfma_f32_32x32x16_bf16 v[240:255], v[52:55], v[124:127], v[240:255]
    v_fmac_f32 v61, s46, v63
    v_cvt_pk_bf16_f32 v51, v60, v61
    v_add_u32 v9, 7168, v8
    s_waitcnt lgkmcnt(0)
    s_nop 1
    v_mfma_f32_32x32x16_bf16 v[128:143], v[48:51], v[64:67], v[128:143]
    s_lshl_b32 s42, s54, 3
    s_add_u32 m0, s49, s42
    s_mul_i32 s38, s54, 688
    s_add_u32 s38, s38, s48
    buffer_load_dwordx4 v26, s[12:15], s38 offen lds
    v_mfma_f32_32x32x16_bf16 v[144:159], v[48:51], v[68:71], v[144:159]
    ds_read_b128 v[96:99], v21 offset:0
    ds_read_b128 v[100:103], v21 offset:4096
    ds_read_b128 v[104:107], v21 offset:8192
    ds_read_b128 v[108:111], v21 offset:12288
    v_lshlrev_b32 v56, 16, v40
    v_mfma_f32_32x32x16_bf16 v[160:175], v[48:51], v[72:75], v[160:175]
    ds_read_b128 v[112:115], v21 offset:16384
    ds_read_b128 v[116:119], v21 offset:20480
    v_and_b32 v57, 0xffff0000, v40
    v_lshlrev_b32 v58, 16, v44
    v_and_b32 v59, 0xffff0000, v44
    v_mfma_f32_16x16x32_bf16 a[128:131], v[28:31], v[40:43], a[128:131]
    v_fmac_f32 v56, s46, v58
    v_mfma_f32_32x32x16_bf16 a[148:163], v[40:43], v[40:43], a[148:163]
    ds_read_b128 v[120:123], v21 offset:24576
    ds_read_b128 v[124:127], v21 offset:28672
    v_fmac_f32 v57, s46, v59
    v_cvt_pk_bf16_f32 v52, v56, v57
    v_lshlrev_b32 v60, 16, v41
    v_mfma_f32_32x32x16_bf16 v[176:191], v[48:51], v[76:79], v[176:191]
    ds_read_b128 v[32:35], v18 offset:32768
    ds_read_b128 v[36:39], v18 offset:49152
    v_and_b32 v61, 0xffff0000, v41
    v_lshlrev_b32 v62, 16, v45
    v_and_b32 v63, 0xffff0000, v45
    v_mfma_f32_32x32x16_bf16 v[192:207], v[48:51], v[80:83], v[192:207]
    ds_read_b128 a[56:59], v18 offset:32768
    ds_read_b128 a[120:123], v18 offset:49152
    v_fmac_f32 v60, s46, v62
    v_fmac_f32 v61, s46, v63
    v_cvt_pk_bf16_f32 v53, v60, v61
    v_mfma_f32_32x32x16_bf16 v[208:223], v[48:51], v[84:87], v[208:223]
    v_lshlrev_b32 v56, 16, v42
    v_and_b32 v57, 0xffff0000, v42
    v_lshlrev_b32 v58, 16, v46
    v_and_b32 v59, 0xffff0000, v46
    v_fmac_f32 v56, s46, v58
    v_mfma_f32_16x16x32_bf16 a[128:131], v[28:31], v[44:47], a[128:131]
    v_fmac_f32 v57, s46, v59
    v_mfma_f32_32x32x16_bf16 a[148:163], v[44:47], v[44:47], a[148:163]
    s_add_u32 m0, m0, 16384
    s_nop 0
    buffer_load_dwordx4 v27, s[16:19], s38 offen lds
    v_cvt_pk_bf16_f32 v54, v56, v57
    v_lshlrev_b32 v60, 16, v43
    v_mfma_f32_32x32x16_bf16 v[224:239], v[48:51], v[88:91], v[224:239]
    v_and_b32 v61, 0xffff0000, v43
    v_lshlrev_b32 v62, 16, v47
    v_and_b32 v63, 0xffff0000, v47
    v_fmac_f32 v60, s46, v62
    v_fmac_f32 v61, s46, v63
    v_mfma_f32_32x32x16_bf16 v[240:255], v[48:51], v[92:95], v[240:255]
    v_cvt_pk_bf16_f32 v55, v60, v61
    v_add_u32 v10, 14336, v8
    v_add_u32 v11, 21504, v8
    s_waitcnt lgkmcnt(0)
    s_nop 1
    v_mfma_f32_32x32x16_bf16 v[128:143], v[52:55], v[96:99], v[128:143]
    ds_read_b128 v[64:67], v22 offset:0
    ds_read_b128 v[68:71], v22 offset:4096
    v_lshlrev_b32 v56, 16, v32
    v_and_b32 v57, 0xffff0000, v32
    v_lshlrev_b32 v58, 16, v36
    v_mfma_f32_32x32x16_bf16 v[144:159], v[52:55], v[100:103], v[144:159]
    ds_read_b128 v[72:75], v22 offset:8192
    ds_read_b128 v[76:79], v22 offset:12288
    v_and_b32 v59, 0xffff0000, v36
    v_fmac_f32 v56, s46, v58
    v_fmac_f32 v57, s46, v59
    v_mfma_f32_32x32x16_bf16 v[160:175], v[52:55], v[104:107], v[160:175]
    ds_read_b128 v[80:83], v22 offset:16384
    ds_read_b128 v[84:87], v22 offset:20480
    v_cvt_pk_bf16_f32 v48, v56, v57
    v_lshlrev_b32 v60, 16, v33
    v_and_b32 v61, 0xffff0000, v33
    v_mfma_f32_16x16x32_bf16 a[128:131], v[28:31], v[32:35], a[128:131]
    v_lshlrev_b32 v62, 16, v37
    v_mfma_f32_32x32x16_bf16 a[148:163], v[32:35], v[32:35], a[148:163]
    ds_read_b128 v[88:91], v22 offset:24576
    ds_read_b128 v[92:95], v22 offset:28672
    v_and_b32 v63, 0xffff0000, v37
    v_fmac_f32 v60, s46, v62
    v_fmac_f32 v61, s46, v63
    v_mfma_f32_32x32x16_bf16 v[176:191], v[52:55], v[108:111], v[176:191]
    ds_read_b128 v[40:43], v19 offset:32768
    ds_read_b128 v[44:47], v19 offset:49152
    v_cvt_pk_bf16_f32 v49, v60, v61
    v_lshlrev_b32 v56, 16, v34
    v_and_b32 v57, 0xffff0000, v34
    v_mfma_f32_32x32x16_bf16 v[192:207], v[52:55], v[112:115], v[192:207]
    s_lshl_b32 s42, s55, 3
    s_add_u32 m0, s49, s42
    s_mul_i32 s38, s55, 688
    s_add_u32 s38, s38, s48
    buffer_load_dwordx4 v26, s[12:15], s38 offen lds
    v_mfma_f32_32x32x16_bf16 v[208:223], v[52:55], v[116:119], v[208:223]
    ds_read_b128 a[60:63], v19 offset:32768
    ds_read_b128 a[124:127], v19 offset:49152
    v_lshlrev_b32 v58, 16, v38
    v_and_b32 v59, 0xffff0000, v38
    v_fmac_f32 v56, s46, v58
    v_mfma_f32_16x16x32_bf16 a[128:131], v[28:31], v[36:39], a[128:131]
    v_fmac_f32 v57, s46, v59
    v_mfma_f32_32x32x16_bf16 a[148:163], v[36:39], v[36:39], a[148:163]
    v_cvt_pk_bf16_f32 v50, v56, v57
    v_lshlrev_b32 v60, 16, v35
    v_and_b32 v61, 0xffff0000, v35
    v_lshlrev_b32 v62, 16, v39
    v_and_b32 v63, 0xffff0000, v39
    v_mfma_f32_32x32x16_bf16 v[224:239], v[52:55], v[120:123], v[224:239]
    v_fmac_f32 v60, s46, v62
    v_fmac_f32 v61, s46, v63
    v_cvt_pk_bf16_f32 v51, v60, v61
    v_mfma_f32_32x32x16_bf16 v[240:255], v[52:55], v[124:127], v[240:255]
    s_waitcnt lgkmcnt(0)
    s_nop 1
    v_mfma_f32_32x32x16_bf16 v[128:143], v[48:51], v[64:67], v[128:143]
    ds_read_b128 v[96:99], v23 offset:0
    ds_read_b128 v[100:103], v23 offset:4096
    v_lshlrev_b32 v56, 16, v40
    v_and_b32 v57, 0xffff0000, v40
    v_lshlrev_b32 v58, 16, v44
    v_mfma_f32_32x32x16_bf16 v[144:159], v[48:51], v[68:71], v[144:159]
    ds_read_b128 v[104:107], v23 offset:8192
    ds_read_b128 v[108:111], v23 offset:12288
    v_and_b32 v59, 0xffff0000, v44
    v_fmac_f32 v56, s46, v58
    v_fmac_f32 v57, s46, v59
    v_mfma_f32_32x32x16_bf16 v[160:175], v[48:51], v[72:75], v[160:175]
    ds_read_b128 v[112:115], v23 offset:16384
    ds_read_b128 v[116:119], v23 offset:20480
    v_cvt_pk_bf16_f32 v52, v56, v57
    v_lshlrev_b32 v60, 16, v41
    v_and_b32 v61, 0xffff0000, v41
    v_mfma_f32_16x16x32_bf16 a[128:131], v[28:31], v[40:43], a[128:131]
    v_lshlrev_b32 v62, 16, v45
    v_mfma_f32_32x32x16_bf16 a[148:163], v[40:43], v[40:43], a[148:163]
    s_add_u32 m0, m0, 16384
    s_nop 0
    buffer_load_dwordx4 v27, s[16:19], s38 offen lds
    ds_read_b128 v[120:123], v23 offset:24576
    ds_read_b128 v[124:127], v23 offset:28672
    v_mfma_f32_32x32x16_bf16 v[176:191], v[48:51], v[76:79], v[176:191]
    v_and_b32 v63, 0xffff0000, v45
    v_fmac_f32 v60, s46, v62
    v_fmac_f32 v61, s46, v63
    v_cvt_pk_bf16_f32 v53, v60, v61
    v_lshlrev_b32 v56, 16, v42
    v_mfma_f32_32x32x16_bf16 v[192:207], v[48:51], v[80:83], v[192:207]
    v_and_b32 v57, 0xffff0000, v42
    v_lshlrev_b32 v58, 16, v46
    v_and_b32 v59, 0xffff0000, v46
    v_fmac_f32 v56, s46, v58
    v_fmac_f32 v57, s46, v59
    v_mfma_f32_32x32x16_bf16 v[208:223], v[48:51], v[84:87], v[208:223]
    v_cvt_pk_bf16_f32 v54, v56, v57
    v_lshlrev_b32 v60, 16, v43
    v_and_b32 v61, 0xffff0000, v43
    v_lshlrev_b32 v62, 16, v47
    v_and_b32 v63, 0xffff0000, v47
    v_mfma_f32_16x16x32_bf16 a[128:131], v[28:31], v[44:47], a[128:131]
    v_fmac_f32 v60, s46, v62
    v_mfma_f32_32x32x16_bf16 a[148:163], v[44:47], v[44:47], a[148:163]
    v_fmac_f32 v61, s46, v63
    v_cvt_pk_bf16_f32 v55, v60, v61
    v_mfma_f32_32x32x16_bf16 v[224:239], v[48:51], v[88:91], v[224:239]
    v_mfma_f32_32x32x16_bf16 v[240:255], v[48:51], v[92:95], v[240:255]
    s_waitcnt lgkmcnt(0)
    s_nop 1
    v_mfma_f32_32x32x16_bf16 v[128:143], v[52:55], v[96:99], v[128:143]
    buffer_load_dword a254, v7, s[4:7], s3 offen
    v_bfe_u32 v4, v1, 2, 2
    v_lshl_add_u32 v4, v3, 3, v4
    v_lshlrev_b32 v4, 5, v4
    v_and_b32 v21, 3, v1
    v_mfma_f32_32x32x16_bf16 v[144:159], v[52:55], v[100:103], v[144:159]
    buffer_load_dword a254, v7, s[4:7], s3 offen offset:128
    v_lshl_add_u32 v4, v21, 3, v4
    v_bfe_u32 v21, v1, 4, 1
    v_mul_u32_u24 v21, 16512, v21
    v_add_u32 v4, v4, v21
    v_mfma_f32_32x32x16_bf16 v[160:175], v[52:55], v[104:107], v[160:175]
    v_add_u32 v20, 98304, v4
    v_xor_b32 v21, 128, v20
    v_add_u32 v22, s43, v20
    v_add_u32 v23, s43, v21
    v_mfma_f32_32x32x16_bf16 v[176:191], v[52:55], v[108:111], v[176:191]
    s_add_u32 s3, s3, 22528
    buffer_load_dword a254, v7, s[4:7], s3 offen
    v_mfma_f32_32x32x16_bf16 v[192:207], v[52:55], v[112:115], v[192:207]
    v_mfma_f32_32x32x16_bf16 v[208:223], v[52:55], v[116:119], v[208:223]
    buffer_load_dword a254, v7, s[4:7], s3 offen offset:128
    v_mfma_f32_32x32x16_bf16 v[224:239], v[52:55], v[120:123], v[224:239]
    v_mfma_f32_32x32x16_bf16 v[240:255], v[52:55], v[124:127], v[240:255]
    s_waitcnt vmcnt(4)
    ds_read_b64_tr_b16 v[96:97], v22 offset:0
    ds_read_b64_tr_b16 v[98:99], v23 offset:0
    ds_read_b64_tr_b16 v[100:101], v22 offset:512
    ds_read_b64_tr_b16 v[102:103], v23 offset:512
    ds_read_b64_tr_b16 v[104:105], v22 offset:1024
    ds_read_b64_tr_b16 v[106:107], v23 offset:1024
    ds_read_b64_tr_b16 v[108:109], v22 offset:1536
    ds_read_b64_tr_b16 v[110:111], v23 offset:1536
    ds_read_b64_tr_b16 v[112:113], v22 offset:2048
    ds_read_b64_tr_b16 v[114:115], v23 offset:2048
    ds_read_b64_tr_b16 v[116:117], v22 offset:2560
    ds_read_b64_tr_b16 v[118:119], v23 offset:2560
    v_accvgpr_read_b32 v57, a128
    v_accvgpr_read_b32 v64, a148
    v_accvgpr_read_b32 v65, a149
    v_accvgpr_read_b32 v66, a150
    v_accvgpr_read_b32 v67, a151
    v_accvgpr_read_b32 v68, a152
    v_accvgpr_read_b32 v69, a153
    v_accvgpr_read_b32 v70, a154
    v_accvgpr_read_b32 v71, a155
    v_accvgpr_read_b32 v72, a156
    v_accvgpr_read_b32 v73, a157
    v_accvgpr_read_b32 v74, a158
    v_accvgpr_read_b32 v75, a159
    v_accvgpr_read_b32 v76, a160
    v_accvgpr_read_b32 v77, a161
    v_accvgpr_read_b32 v78, a162
    v_accvgpr_read_b32 v79, a163
    v_and_b32 v5, 1, v1
    v_cmp_eq_u32 vcc, 1, v5
    v_and_b32 v5, 2, v1
    v_cmp_eq_u32 s[62:63], 2, v5
    ds_read_b64_tr_b16 v[120:121], v22 offset:3072
    ds_read_b64_tr_b16 v[122:123], v23 offset:3072
    ds_read_b64_tr_b16 v[124:125], v22 offset:3584
    ds_read_b64_tr_b16 v[126:127], v23 offset:3584
    v_cndmask_b32 v64, v64, v65, vcc
    v_cndmask_b32 v66, v66, v67, vcc
    v_cndmask_b32 v68, v68, v69, vcc
    v_cndmask_b32 v70, v70, v71, vcc
    v_cndmask_b32 v72, v72, v73, vcc
    v_cndmask_b32 v74, v74, v75, vcc
    v_cndmask_b32 v76, v76, v77, vcc
    v_cndmask_b32 v78, v78, v79, vcc
    v_and_b32 v5, 8, v1
    v_cmp_eq_u32 vcc, 8, v5
    v_cndmask_b32 v64, v64, v66, s[62:63]
    v_cndmask_b32 v68, v68, v70, s[62:63]
    v_cndmask_b32 v72, v72, v74, s[62:63]
    v_cndmask_b32 v76, v76, v78, s[62:63]
    v_and_b32 v5, 16, v1
    v_cmp_eq_u32 s[62:63], 16, v5
    v_cndmask_b32 v64, v64, v68, vcc
    v_cndmask_b32 v72, v72, v76, vcc
    v_bfe_u32 v5, v1, 2, 1
    v_cmp_eq_u32 vcc, v5, v3
    v_cndmask_b32 v64, v64, v72, s[62:63]
    s_nop 0
    v_cndmask_b32 v65, 0, v64, vcc
    s_waitcnt lgkmcnt(0)
    v_mfma_f32_16x16x32_bf16 v[24:27], v[28:31], v[96:99], 0
    v_mov_b32 v5, v57
    v_mov_b32 v4, v65
    v_mfma_f32_16x16x32_bf16 v[24:27], v[28:31], v[100:103], v[24:27]
    s_nop 1
    v_permlane32_swap_b32 v57, v5
    v_mfma_f32_16x16x32_bf16 v[24:27], v[28:31], v[104:107], v[24:27]
    v_permlane32_swap_b32 v65, v4
    v_add_f32 v57, v57, v5
    v_mfma_f32_16x16x32_bf16 v[24:27], v[28:31], v[108:111], v[24:27]
    v_add_f32 v65, v65, v4
    v_mul_f32 v57, 0xbb000000, v57
    v_mfma_f32_16x16x32_bf16 v[24:27], v[28:31], v[112:115], v[24:27]
    v_mul_f32 v65, 0x3b000000, v65
    v_cvt_pk_bf16_f32 v48, v57, v57
    v_mfma_f32_16x16x32_bf16 v[24:27], v[28:31], v[116:119], v[24:27]
    v_fma_f32 v65, -v57, v57, v65
    v_max_f32 v65, 0, v65
    v_mfma_f32_16x16x32_bf16 v[24:27], v[28:31], v[120:123], v[24:27]
    v_cvt_pk_bf16_f32 v65, v65, v65
    v_and_b32 v65, 0xffff0000, v65
    v_mfma_f32_16x16x32_bf16 v[24:27], v[28:31], v[124:127], v[24:27]
    v_add_f32 v65, 0x3727c5ac, v65
    v_cvt_pk_bf16_f32 v65, v65, v65
    v_and_b32 v65, 0xffff0000, v65
    v_sqrt_f32 v65, v65
    s_nop 0
    v_cvt_pk_bf16_f32 v65, v65, v65
    v_and_b32 v65, 0xffff0000, v65
    v_rcp_f32 v56, v65
    v_mul_f32 v62, v65, v65
    v_mul_f32 v58, 0xc0135761, v56
    v_mul_f32 v5, v56, v56
    v_mul_f32 v5, 0x3d372713, v5
    v_mul_f32 v60, v58, v5
    v_mov_b32 v59, v58
    v_mov_b32 v61, v60
    v_mov_b32 v63, v62
    s_add_u32 s36, s43, 49152
    v_lshl_add_u32 v4, v1, 2, s36
    v_lshl_add_u32 v5, v3, 4, s36
    ds_write_b32 v4, v56
    ds_write_b32 v4, v24 offset:1024
    v_mov_b32 v49, 0
    v_mov_b32 v50, 0
    v_mov_b32 v51, 0
    v_lshlrev_b32 v19, 2, v1
    v_add_u32 v19, 49152, v19
    v_lshlrev_b32 v4, 4, v1
    v_add_u32 v4, 131072, v4
    v_add_u32 v16, s43, v4
    s_lshr_b32 s37, s32, 1
    s_and_b32 s42, s32, 1
    s_lshl_b32 s36, s37, 14
    s_lshl_b32 s101, s42, 11
    s_add_u32 s36, s36, s101
    v_add_u32 v17, s36, v4
    s_waitcnt lgkmcnt(1)
    ds_read_b128 v[64:67], v5 offset:0
    ds_read_b128 v[68:71], v5 offset:32
    ds_read_b128 v[72:75], v5 offset:64
    ds_read_b128 v[76:79], v5 offset:96
    v_lshlrev_b32 v18, 4, v2
    v_lshl_add_u32 v18, v3, 18, v18
    s_lshl_b32 s101, s40, 15
    s_lshl_b32 s37, s37, 13
    s_add_u32 s101, s101, s37
    s_lshl_b32 s37, s33, 9
    s_add_u32 s101, s101, s37
    s_lshl_b32 s42, s42, 20
    s_add_u32 s101, s101, s42
    s_add_u32 s101, s101, 6291456
    s_lshl_b32 s3, s33, 3
    s_lshl_b32 s36, s40, 2
    s_add_u32 s3, s3, s36
    s_add_u32 s3, s3, 8916992
    s_waitcnt lgkmcnt(0)
    v_pk_mul_f32 v[128:129], v[128:129], v[64:65]
    v_pk_mul_f32 v[130:131], v[130:131], v[66:67]
    v_pk_mul_f32 v[132:133], v[132:133], v[68:69]
    v_pk_mul_f32 v[134:135], v[134:135], v[70:71]
    s_xor_b32 s97, s94, 0
    s_add_u32 m0, s93, 0
    s_lshl_b32 s96, s97, 16
    s_add_u32 s96, s96, s92
    buffer_load_dwordx4 v8, s[4:7], s96 offen lds
    v_pk_mul_f32 v[136:137], v[136:137], v[72:73]
    v_pk_mul_f32 v[138:139], v[138:139], v[74:75]
    v_pk_mul_f32 v[140:141], v[140:141], v[76:77]
    v_pk_mul_f32 v[142:143], v[142:143], v[78:79]
    v_pk_mul_f32 v[144:145], v[144:145], v[64:65]
    v_pk_mul_f32 v[146:147], v[146:147], v[66:67]
    v_pk_mul_f32 v[148:149], v[148:149], v[68:69]
    v_pk_mul_f32 v[150:151], v[150:151], v[70:71]
    v_pk_mul_f32 v[152:153], v[152:153], v[72:73]
    v_pk_mul_f32 v[154:155], v[154:155], v[74:75]
    v_pk_mul_f32 v[156:157], v[156:157], v[76:77]
    buffer_load_dwordx4 v9, s[4:7], s96 offen offset:1024 lds
    v_pk_mul_f32 v[158:159], v[158:159], v[78:79]
    v_cvt_pk_bf16_f32 v128, v128, v129
    v_cvt_pk_bf16_f32 v129, v130, v131
    v_cvt_pk_bf16_f32 v130, v132, v133
    v_cvt_pk_bf16_f32 v131, v134, v135
    v_cvt_pk_bf16_f32 v132, v136, v137
    v_cvt_pk_bf16_f32 v133, v138, v139
    v_cvt_pk_bf16_f32 v134, v140, v141
    v_cvt_pk_bf16_f32 v135, v142, v143
    v_cvt_pk_bf16_f32 v136, v144, v145
    v_cvt_pk_bf16_f32 v137, v146, v147
    buffer_load_dwordx4 v10, s[4:7], s96 offen offset:2048 lds
    v_cvt_pk_bf16_f32 v138, v148, v149
    v_cvt_pk_bf16_f32 v139, v150, v151
    v_cvt_pk_bf16_f32 v140, v152, v153
    v_cvt_pk_bf16_f32 v141, v154, v155
    v_cvt_pk_bf16_f32 v142, v156, v157
    v_cvt_pk_bf16_f32 v143, v158, v159
    v_pk_mul_f32 v[160:161], v[160:161], v[64:65]
    v_pk_mul_f32 v[162:163], v[162:163], v[66:67]
    v_pk_mul_f32 v[164:165], v[164:165], v[68:69]
    v_pk_mul_f32 v[166:167], v[166:167], v[70:71]
    v_pk_mul_f32 v[168:169], v[168:169], v[72:73]
    buffer_load_dwordx4 v11, s[4:7], s96 offen offset:3072 lds
    v_pk_mul_f32 v[170:171], v[170:171], v[74:75]
    v_pk_mul_f32 v[172:173], v[172:173], v[76:77]
    v_pk_mul_f32 v[174:175], v[174:175], v[78:79]
    v_pk_mul_f32 v[176:177], v[176:177], v[64:65]
    v_pk_mul_f32 v[178:179], v[178:179], v[66:67]
    v_pk_mul_f32 v[180:181], v[180:181], v[68:69]
    v_pk_mul_f32 v[182:183], v[182:183], v[70:71]
    v_pk_mul_f32 v[184:185], v[184:185], v[72:73]
    v_pk_mul_f32 v[186:187], v[186:187], v[74:75]
    v_pk_mul_f32 v[188:189], v[188:189], v[76:77]
    v_pk_mul_f32 v[190:191], v[190:191], v[78:79]
    s_xor_b32 s97, s94, 1
    s_add_u32 m0, s93, 16384
    s_lshl_b32 s96, s97, 16
    s_add_u32 s96, s96, s92
    buffer_load_dwordx4 v8, s[4:7], s96 offen lds
    v_cvt_pk_bf16_f32 v160, v160, v161
    v_cvt_pk_bf16_f32 v161, v162, v163
    v_cvt_pk_bf16_f32 v162, v164, v165
    v_cvt_pk_bf16_f32 v163, v166, v167
    v_cvt_pk_bf16_f32 v164, v168, v169
    v_cvt_pk_bf16_f32 v165, v170, v171
    v_cvt_pk_bf16_f32 v166, v172, v173
    v_cvt_pk_bf16_f32 v167, v174, v175
    v_cvt_pk_bf16_f32 v168, v176, v177
    v_cvt_pk_bf16_f32 v169, v178, v179
    v_cvt_pk_bf16_f32 v170, v180, v181
    buffer_load_dwordx4 v9, s[4:7], s96 offen offset:1024 lds
    v_cvt_pk_bf16_f32 v171, v182, v183
    v_cvt_pk_bf16_f32 v172, v184, v185
    v_cvt_pk_bf16_f32 v173, v186, v187
    v_cvt_pk_bf16_f32 v174, v188, v189
    v_cvt_pk_bf16_f32 v175, v190, v191
    v_mfma_f32_32x32x16_bf16 v[144:159], a[132:135], v[128:131], 0
    v_mfma_f32_32x32x16_bf16 v[112:127], a[132:135], v[136:139], 0
    v_mfma_f32_32x32x16_bf16 v[144:159], a[136:139], v[132:135], v[144:159]
    v_mfma_f32_32x32x16_bf16 v[112:127], a[136:139], v[140:143], v[112:127]
    v_mfma_f32_32x32x16_bf16 v[144:159], a[164:167], v[136:139], v[144:159]
    v_mfma_f32_32x32x16_bf16 v[112:127], a[140:143], v[128:131], v[112:127]
    buffer_load_dwordx4 v10, s[4:7], s96 offen offset:2048 lds
    v_mfma_f32_32x32x16_bf16 v[144:159], a[168:171], v[140:143], v[144:159]
    v_mfma_f32_32x32x16_bf16 v[112:127], a[144:147], v[132:135], v[112:127]
    v_pk_mul_f32 v[192:193], v[192:193], v[64:65]
    v_pk_mul_f32 v[194:195], v[194:195], v[66:67]
    v_pk_mul_f32 v[196:197], v[196:197], v[68:69]
    v_pk_mul_f32 v[198:199], v[198:199], v[70:71]
    v_pk_mul_f32 v[200:201], v[200:201], v[72:73]
    v_pk_mul_f32 v[202:203], v[202:203], v[74:75]
    v_pk_mul_f32 v[204:205], v[204:205], v[76:77]
    v_pk_mul_f32 v[206:207], v[206:207], v[78:79]
    v_pk_mul_f32 v[208:209], v[208:209], v[64:65]
    buffer_load_dwordx4 v11, s[4:7], s96 offen offset:3072 lds
    v_pk_mul_f32 v[210:211], v[210:211], v[66:67]
    v_pk_mul_f32 v[212:213], v[212:213], v[68:69]
    v_pk_mul_f32 v[214:215], v[214:215], v[70:71]
    v_pk_mul_f32 v[216:217], v[216:217], v[72:73]
    v_pk_mul_f32 v[218:219], v[218:219], v[74:75]
    v_pk_mul_f32 v[220:221], v[220:221], v[76:77]
    v_pk_mul_f32 v[222:223], v[222:223], v[78:79]
    v_cvt_pk_bf16_f32 v192, v192, v193
    v_cvt_pk_bf16_f32 v193, v194, v195
    v_cvt_pk_bf16_f32 v194, v196, v197
    v_cvt_pk_bf16_f32 v195, v198, v199
    s_xor_b32 s97, s94, 2
    s_add_u32 m0, s93, 32768
    s_lshl_b32 s96, s97, 16
    s_add_u32 s96, s96, s92
    buffer_load_dwordx4 v8, s[4:7], s96 offen lds
    v_cvt_pk_bf16_f32 v196, v200, v201
    v_cvt_pk_bf16_f32 v197, v202, v203
    v_cvt_pk_bf16_f32 v198, v204, v205
    v_cvt_pk_bf16_f32 v199, v206, v207
    v_cvt_pk_bf16_f32 v200, v208, v209
    v_cvt_pk_bf16_f32 v201, v210, v211
    v_cvt_pk_bf16_f32 v202, v212, v213
    v_cvt_pk_bf16_f32 v203, v214, v215
    v_cvt_pk_bf16_f32 v204, v216, v217
    v_cvt_pk_bf16_f32 v205, v218, v219
    v_cvt_pk_bf16_f32 v206, v220, v221
    buffer_load_dwordx4 v9, s[4:7], s96 offen offset:1024 lds
    v_cvt_pk_bf16_f32 v207, v222, v223
    v_pk_mul_f32 v[224:225], v[224:225], v[64:65]
    v_pk_mul_f32 v[226:227], v[226:227], v[66:67]
    v_pk_mul_f32 v[228:229], v[228:229], v[68:69]
    v_pk_mul_f32 v[230:231], v[230:231], v[70:71]
    v_pk_mul_f32 v[232:233], v[232:233], v[72:73]
    v_pk_mul_f32 v[234:235], v[234:235], v[74:75]
    v_pk_mul_f32 v[236:237], v[236:237], v[76:77]
    v_pk_mul_f32 v[238:239], v[238:239], v[78:79]
    v_pk_mul_f32 v[240:241], v[240:241], v[64:65]
    v_pk_mul_f32 v[242:243], v[242:243], v[66:67]
    buffer_load_dwordx4 v10, s[4:7], s96 offen offset:2048 lds
    v_pk_mul_f32 v[244:245], v[244:245], v[68:69]
    v_pk_mul_f32 v[246:247], v[246:247], v[70:71]
    v_pk_mul_f32 v[248:249], v[248:249], v[72:73]
    v_pk_mul_f32 v[250:251], v[250:251], v[74:75]
    v_pk_mul_f32 v[252:253], v[252:253], v[76:77]
    v_pk_mul_f32 v[254:255], v[254:255], v[78:79]
    v_cvt_pk_bf16_f32 v224, v224, v225
    v_cvt_pk_bf16_f32 v225, v226, v227
    v_cvt_pk_bf16_f32 v226, v228, v229
    v_cvt_pk_bf16_f32 v227, v230, v231
    v_cvt_pk_bf16_f32 v228, v232, v233
    buffer_load_dwordx4 v11, s[4:7], s96 offen offset:3072 lds
    v_cvt_pk_bf16_f32 v229, v234, v235
    v_cvt_pk_bf16_f32 v230, v236, v237
    v_cvt_pk_bf16_f32 v231, v238, v239
    v_cvt_pk_bf16_f32 v232, v240, v241
    v_cvt_pk_bf16_f32 v233, v242, v243
    v_cvt_pk_bf16_f32 v234, v244, v245
    v_cvt_pk_bf16_f32 v235, v246, v247
    v_cvt_pk_bf16_f32 v236, v248, v249
    v_cvt_pk_bf16_f32 v237, v250, v251
    v_cvt_pk_bf16_f32 v238, v252, v253
    v_cvt_pk_bf16_f32 v239, v254, v255
    v_mfma_f32_32x32x16_bf16 v[176:191], a[132:135], v[160:163], 0
    v_cvt_pk_bf16_f32 v144, v144, v112
    v_cvt_pk_bf16_f32 v145, v145, v113
    v_cvt_pk_bf16_f32 v146, v146, v114
    v_cvt_pk_bf16_f32 v147, v147, v115
    ds_write_b128 v16, v[144:147] offset:0
    v_mfma_f32_32x32x16_bf16 v[80:95], a[132:135], v[168:171], 0
    v_cvt_pk_bf16_f32 v148, v148, v116
    v_cvt_pk_bf16_f32 v149, v149, v117
    v_cvt_pk_bf16_f32 v150, v150, v118
    v_cvt_pk_bf16_f32 v151, v151, v119
    ds_write_b128 v16, v[148:151] offset:1024
    v_mfma_f32_32x32x16_bf16 v[176:191], a[136:139], v[164:167], v[176:191]
    v_cvt_pk_bf16_f32 v152, v152, v120
    v_cvt_pk_bf16_f32 v153, v153, v121
    v_cvt_pk_bf16_f32 v154, v154, v122
    v_cvt_pk_bf16_f32 v155, v155, v123
    ds_write_b128 v16, v[152:155] offset:2048
    v_mfma_f32_32x32x16_bf16 v[80:95], a[136:139], v[172:175], v[80:95]
    v_cvt_pk_bf16_f32 v156, v156, v124
    v_cvt_pk_bf16_f32 v157, v157, v125
    v_cvt_pk_bf16_f32 v158, v158, v126
    v_cvt_pk_bf16_f32 v159, v159, v127
    ds_write_b128 v16, v[156:159] offset:3072
    v_mfma_f32_32x32x16_bf16 v[176:191], a[164:167], v[168:171], v[176:191]
    v_mfma_f32_32x32x16_bf16 v[80:95], a[140:143], v[160:163], v[80:95]
    v_mfma_f32_32x32x16_bf16 v[176:191], a[168:171], v[172:175], v[176:191]
    v_mfma_f32_32x32x16_bf16 v[80:95], a[144:147], v[164:167], v[80:95]
    v_mfma_f32_32x32x16_bf16 v[208:223], a[132:135], v[192:195], 0
    v_mfma_f32_32x32x16_bf16 v[96:111], a[132:135], v[200:203], 0
    s_nop 9
    v_mfma_f32_32x32x16_bf16 v[208:223], a[136:139], v[196:199], v[208:223]
    v_cvt_pk_bf16_f32 v176, v176, v80
    v_cvt_pk_bf16_f32 v177, v177, v81
    v_cvt_pk_bf16_f32 v178, v178, v82
    v_cvt_pk_bf16_f32 v179, v179, v83
    ds_write_b128 v16, v[176:179] offset:16384
    v_mfma_f32_32x32x16_bf16 v[96:111], a[136:139], v[204:207], v[96:111]
    v_cvt_pk_bf16_f32 v180, v180, v84
    v_cvt_pk_bf16_f32 v181, v181, v85
    v_cvt_pk_bf16_f32 v182, v182, v86
    v_cvt_pk_bf16_f32 v183, v183, v87
    ds_write_b128 v16, v[180:183] offset:17408
    v_mfma_f32_32x32x16_bf16 v[208:223], a[164:167], v[200:203], v[208:223]
    v_cvt_pk_bf16_f32 v184, v184, v88
    v_cvt_pk_bf16_f32 v185, v185, v89
    v_cvt_pk_bf16_f32 v186, v186, v90
    v_cvt_pk_bf16_f32 v187, v187, v91
    ds_write_b128 v16, v[184:187] offset:18432
    v_mfma_f32_32x32x16_bf16 v[96:111], a[140:143], v[192:195], v[96:111]
    v_cvt_pk_bf16_f32 v188, v188, v92
    v_cvt_pk_bf16_f32 v189, v189, v93
    v_cvt_pk_bf16_f32 v190, v190, v94
    v_cvt_pk_bf16_f32 v191, v191, v95
    ds_write_b128 v16, v[188:191] offset:19456
    v_mfma_f32_32x32x16_bf16 v[208:223], a[168:171], v[204:207], v[208:223]
    v_mfma_f32_32x32x16_bf16 v[96:111], a[144:147], v[196:199], v[96:111]
    s_waitcnt lgkmcnt(0)
    s_barrier
    v_subrev_u32 v16, 65536, v16
    v_mfma_f32_32x32x16_bf16 v[240:255], a[132:135], v[224:227], 0
    ds_read_b128 v[128:131], v17 offset:0
    ds_read_b128 v[132:135], v17 offset:4096
    ds_read_b128 v[136:139], v17 offset:8192
    ds_read_b128 v[140:143], v17 offset:12288
    ds_read_b128 v[160:163], v17 offset:1024
    v_mfma_f32_32x32x16_bf16 v[32:47], a[132:135], v[232:235], 0
    ds_read_b128 v[164:167], v17 offset:5120
    ds_read_b128 v[168:171], v17 offset:9216
    ds_read_b128 v[172:175], v17 offset:13312
    v_mfma_f32_32x32x16_bf16 v[240:255], a[136:139], v[228:231], v[240:255]
    v_mfma_f32_32x32x16_bf16 v[32:47], a[136:139], v[236:239], v[32:47]
    v_cvt_pk_bf16_f32 v208, v208, v96
    v_cvt_pk_bf16_f32 v209, v209, v97
    v_cvt_pk_bf16_f32 v210, v210, v98
    v_cvt_pk_bf16_f32 v211, v211, v99
    ds_write_b128 v16, v[208:211] offset:0
    v_mfma_f32_32x32x16_bf16 v[240:255], a[164:167], v[232:235], v[240:255]
    v_cvt_pk_bf16_f32 v212, v212, v100
    v_cvt_pk_bf16_f32 v213, v213, v101
    v_cvt_pk_bf16_f32 v214, v214, v102
    v_cvt_pk_bf16_f32 v215, v215, v103
    ds_write_b128 v16, v[212:215] offset:1024
    v_mfma_f32_32x32x16_bf16 v[32:47], a[140:143], v[224:227], v[32:47]
    v_cvt_pk_bf16_f32 v216, v216, v104
    v_cvt_pk_bf16_f32 v217, v217, v105
    v_cvt_pk_bf16_f32 v218, v218, v106
    v_cvt_pk_bf16_f32 v219, v219, v107
    ds_write_b128 v16, v[216:219] offset:2048
    v_mfma_f32_32x32x16_bf16 v[240:255], a[168:171], v[236:239], v[240:255]
    v_cvt_pk_bf16_f32 v220, v220, v108
    v_cvt_pk_bf16_f32 v221, v221, v109
    v_cvt_pk_bf16_f32 v222, v222, v110
    v_cvt_pk_bf16_f32 v223, v223, v111
    ds_write_b128 v16, v[220:223] offset:3072
    v_mfma_f32_32x32x16_bf16 v[32:47], a[144:147], v[228:231], v[32:47]
    s_waitcnt lgkmcnt(8)
    v_swap_b32 v129, v132
    v_swap_b32 v130, v136
    v_swap_b32 v131, v140
    v_swap_b32 v134, v137
    v_swap_b32 v135, v141
    v_swap_b32 v139, v142
    s_add_u32 s64, s101, 0
    buffer_store_dwordx4 v[128:131], v18, s[20:23], s64 offen sc1
    s_add_u32 s64, s101, 65536
    buffer_store_dwordx4 v[132:135], v18, s[20:23], s64 offen sc1
    s_add_u32 s64, s101, 131072
    buffer_store_dwordx4 v[136:139], v18, s[20:23], s64 offen sc1
    s_add_u32 s64, s101, 196608
    buffer_store_dwordx4 v[140:143], v18, s[20:23], s64 offen sc1
    v_cvt_pk_bf16_f32 v240, v240, v32
    v_cvt_pk_bf16_f32 v241, v241, v33
    v_cvt_pk_bf16_f32 v242, v242, v34
    v_cvt_pk_bf16_f32 v243, v243, v35
    ds_write_b128 v16, v[240:243] offset:16384
    v_cvt_pk_bf16_f32 v244, v244, v36
    v_cvt_pk_bf16_f32 v245, v245, v37
    v_cvt_pk_bf16_f32 v246, v246, v38
    v_cvt_pk_bf16_f32 v247, v247, v39
    ds_write_b128 v16, v[244:247] offset:17408
    v_cvt_pk_bf16_f32 v248, v248, v40
    v_cvt_pk_bf16_f32 v249, v249, v41
    v_cvt_pk_bf16_f32 v250, v250, v42
    v_cvt_pk_bf16_f32 v251, v251, v43
    ds_write_b128 v16, v[248:251] offset:18432
    v_cvt_pk_bf16_f32 v252, v252, v44
    v_cvt_pk_bf16_f32 v253, v253, v45
    v_cvt_pk_bf16_f32 v254, v254, v46
    v_cvt_pk_bf16_f32 v255, v255, v47
    ds_write_b128 v16, v[252:255] offset:19456
    s_lshl_b32 s36, s52, 4
    v_add_u32 v64, s36, v20
    v_add_u32 v65, s36, v21
    s_lshl_b32 s36, s53, 4
    v_add_u32 v66, s36, v20
    v_add_u32 v67, s36, v21
    s_lshl_b32 s36, s54, 4
    v_add_u32 v68, s36, v20
    v_add_u32 v69, s36, v21
    s_lshl_b32 s36, s55, 4
    v_add_u32 v70, s36, v20
    v_add_u32 v71, s36, v21
    s_mul_i32 s55, s35, 86
    s_add_u32 s55, s55, s40
    s_add_u32 s55, s55, 84
    s_lshl_b32 s55, s55, 10
    s_waitcnt lgkmcnt(0)
    s_barrier
    v_subrev_u32 v17, 65536, v17
    v_mov_b32 v240, v64
    v_mov_b32 v241, v65
    v_mov_b32 v242, v66
    v_mov_b32 v243, v67
    v_mov_b32 v244, v68
    v_mov_b32 v245, v69
    v_mov_b32 v246, v70
    v_mov_b32 v247, v71
    ds_read_b128 v[192:195], v17 offset:0
    ds_read_b128 v[196:199], v17 offset:4096
    ds_read_b128 v[200:203], v17 offset:8192
    ds_read_b128 v[204:207], v17 offset:12288
    ds_read_b128 v[224:227], v17 offset:1024
    ds_read_b128 v[228:231], v17 offset:5120
    ds_read_b128 v[232:235], v17 offset:9216
    ds_read_b128 v[236:239], v17 offset:13312
    ds_read_b32 v248, v19 offset:1024
    ds_read_b32 v249, v19 offset:5120
    ds_read_b32 v250, v19 offset:9216
    ds_read_b32 v251, v19 offset:13312
    v_swap_b32 v161, v164
    v_swap_b32 v162, v168
    v_swap_b32 v163, v172
    v_swap_b32 v166, v169
    v_swap_b32 v167, v173
    v_swap_b32 v171, v174
    s_add_u32 s64, s101, 524288
    buffer_store_dwordx4 v[160:163], v18, s[20:23], s64 offen sc1
    s_add_u32 s64, s101, 589824
    buffer_store_dwordx4 v[164:167], v18, s[20:23], s64 offen sc1
    s_add_u32 s64, s101, 655360
    buffer_store_dwordx4 v[168:171], v18, s[20:23], s64 offen sc1
    s_add_u32 s64, s101, 720896
    buffer_store_dwordx4 v[172:175], v18, s[20:23], s64 offen sc1
    ds_read_b64_tr_b16 v[176:177], v240 offset:0
    ds_read_b64_tr_b16 v[178:179], v241 offset:0
    ds_read_b64_tr_b16 v[180:181], v240 offset:512
    ds_read_b64_tr_b16 v[182:183], v241 offset:512
    ds_read_b64_tr_b16 v[184:185], v240 offset:1024
    ds_read_b64_tr_b16 v[186:187], v241 offset:1024
    s_waitcnt lgkmcnt(4)
    v_mfma_f32_32x32x16_bf16 v[144:159], v[176:179], a[0:3], 0
    ds_read_b64_tr_b16 v[188:189], v240 offset:1536
    ds_read_b64_tr_b16 v[190:191], v241 offset:1536
    v_add_f32 v248, v248, v249
    v_add_f32 v250, v250, v251
    s_waitcnt lgkmcnt(4)
    v_mfma_f32_32x32x16_bf16 v[144:159], v[180:183], a[4:7], v[144:159]
    ds_read_b64_tr_b16 v[176:177], v242 offset:0
    ds_read_b64_tr_b16 v[178:179], v243 offset:0
    v_add_f32 v248, v248, v250
    v_cvt_pk_bf16_f32 v249, v248, v248
    s_waitcnt lgkmcnt(4)
    v_mfma_f32_32x32x16_bf16 v[144:159], v[184:187], a[8:11], v[144:159]
    ds_read_b64_tr_b16 v[180:181], v242 offset:512
    ds_read_b64_tr_b16 v[182:183], v243 offset:512
    v_and_b32 v249, 0xffff0000, v249
    v_sub_f32 v249, v248, v249
    s_waitcnt lgkmcnt(4)
    v_mfma_f32_32x32x16_bf16 v[144:159], v[188:191], a[12:15], v[144:159]
    ds_read_b64_tr_b16 v[184:185], v242 offset:1024
    ds_read_b64_tr_b16 v[186:187], v243 offset:1024
    v_cvt_pk_bf16_f32 v28, v248, v249
    s_waitcnt lgkmcnt(4)
    v_mfma_f32_32x32x16_bf16 v[144:159], v[176:179], a[16:19], v[144:159]
    ds_read_b64_tr_b16 v[188:189], v242 offset:1536
    ds_read_b64_tr_b16 v[190:191], v243 offset:1536
    v_swap_b32 v193, v196
    s_waitcnt lgkmcnt(4)
    v_mfma_f32_32x32x16_bf16 v[144:159], v[180:183], a[20:23], v[144:159]
    ds_read_b64_tr_b16 v[176:177], v244 offset:0
    ds_read_b64_tr_b16 v[178:179], v245 offset:0
    v_swap_b32 v194, v200
    s_waitcnt lgkmcnt(4)
    v_mfma_f32_32x32x16_bf16 v[144:159], v[184:187], a[24:27], v[144:159]
    ds_read_b64_tr_b16 v[180:181], v244 offset:512
    ds_read_b64_tr_b16 v[182:183], v245 offset:512
    v_swap_b32 v195, v204
    s_waitcnt lgkmcnt(4)
    v_mfma_f32_32x32x16_bf16 v[144:159], v[188:191], a[28:31], v[144:159]
    ds_read_b64_tr_b16 v[184:185], v244 offset:1024
    ds_read_b64_tr_b16 v[186:187], v245 offset:1024
    v_swap_b32 v198, v201
    s_waitcnt lgkmcnt(4)
    v_mfma_f32_32x32x16_bf16 v[144:159], v[176:179], a[32:35], v[144:159]
    ds_read_b64_tr_b16 v[188:189], v244 offset:1536
    ds_read_b64_tr_b16 v[190:191], v245 offset:1536
    v_swap_b32 v199, v205
    s_waitcnt lgkmcnt(4)
    v_mfma_f32_32x32x16_bf16 v[144:159], v[180:183], a[36:39], v[144:159]
    ds_read_b64_tr_b16 v[176:177], v246 offset:0
    ds_read_b64_tr_b16 v[178:179], v247 offset:0
    v_swap_b32 v203, v206
    s_waitcnt lgkmcnt(4)
    v_mfma_f32_32x32x16_bf16 v[144:159], v[184:187], a[40:43], v[144:159]
    ds_read_b64_tr_b16 v[180:181], v246 offset:512
    ds_read_b64_tr_b16 v[182:183], v247 offset:512
    s_mov_b32 s16, s20
    s_mov_b32 s17, s21
    s_waitcnt lgkmcnt(4)
    v_mfma_f32_32x32x16_bf16 v[144:159], v[188:191], a[44:47], v[144:159]
    ds_read_b64_tr_b16 v[184:185], v246 offset:1024
    ds_read_b64_tr_b16 v[186:187], v247 offset:1024
    s_mov_b32 s18, 5636096
    s_mov_b32 s19, 0x20000
    s_waitcnt lgkmcnt(4)
    v_mfma_f32_32x32x16_bf16 v[144:159], v[176:179], a[48:51], v[144:159]
    ds_read_b64_tr_b16 v[188:189], v246 offset:1536
    ds_read_b64_tr_b16 v[190:191], v247 offset:1536
    s_and_b32 s40, s32, 1
    s_lshr_b32 s41, s32, 1
    s_waitcnt lgkmcnt(4)
    v_mfma_f32_32x32x16_bf16 v[144:159], v[180:183], a[52:55], v[144:159]
    ds_read_b64_tr_b16 v[176:177], v240 offset:8192
    ds_read_b64_tr_b16 v[178:179], v241 offset:8192
    v_lshlrev_b32 v6, 4, v1
    s_lshl_b32 s42, s40, 5
    s_waitcnt lgkmcnt(4)
    v_mfma_f32_32x32x16_bf16 v[144:159], v[184:187], a[56:59], v[144:159]
    ds_read_b64_tr_b16 v[180:181], v240 offset:8704
    ds_read_b64_tr_b16 v[182:183], v241 offset:8704
    s_add_u32 s42, s42, s99
    s_mul_i32 s43, s42, 88064
    s_waitcnt lgkmcnt(4)
    v_mfma_f32_32x32x16_bf16 v[144:159], v[188:191], a[60:63], v[144:159]
    ds_read_b64_tr_b16 v[184:185], v240 offset:9216
    ds_read_b64_tr_b16 v[186:187], v241 offset:9216
    s_mul_i32 s36, s41, 45056
    s_add_u32 s43, s43, s36
    s_waitcnt lgkmcnt(4)
    v_mfma_f32_32x32x16_bf16 v[144:159], v[176:179], a[64:67], v[144:159]
    ds_read_b64_tr_b16 v[188:189], v240 offset:9728
    ds_read_b64_tr_b16 v[190:191], v241 offset:9728
    v_and_b32 v2, 31, v1
    v_lshrrev_b32 v3, 5, v1
    s_waitcnt lgkmcnt(4)
    v_mfma_f32_32x32x16_bf16 v[144:159], v[180:183], a[68:71], v[144:159]
    ds_read_b64_tr_b16 v[176:177], v242 offset:8192
    ds_read_b64_tr_b16 v[178:179], v243 offset:8192
    s_lshl_b32 s36, s100, 1
    s_add_u32 s36, s36, s41
    s_waitcnt lgkmcnt(4)
    v_mfma_f32_32x32x16_bf16 v[144:159], v[184:187], a[72:75], v[144:159]
    ds_read_b64_tr_b16 v[180:181], v242 offset:8704
    ds_read_b64_tr_b16 v[182:183], v243 offset:8704
    s_lshl_b32 s36, s36, 5
    v_add_u32 v4, s36, v2
    s_waitcnt lgkmcnt(4)
    v_mfma_f32_32x32x16_bf16 v[144:159], v[188:191], a[76:79], v[144:159]
    ds_read_b64_tr_b16 v[184:185], v242 offset:9216
    ds_read_b64_tr_b16 v[186:187], v243 offset:9216
    s_waitcnt lgkmcnt(4)
    v_mfma_f32_32x32x16_bf16 v[144:159], v[176:179], a[80:83], v[144:159]
    ds_read_b64_tr_b16 v[188:189], v242 offset:9728
    ds_read_b64_tr_b16 v[190:191], v243 offset:9728
    s_waitcnt lgkmcnt(4)
    v_mfma_f32_32x32x16_bf16 v[144:159], v[180:183], a[84:87], v[144:159]
    ds_read_b64_tr_b16 v[176:177], v244 offset:8192
    ds_read_b64_tr_b16 v[178:179], v245 offset:8192
    s_waitcnt lgkmcnt(4)
    v_mfma_f32_32x32x16_bf16 v[144:159], v[184:187], a[88:91], v[144:159]
    ds_read_b64_tr_b16 v[180:181], v244 offset:8704
    ds_read_b64_tr_b16 v[182:183], v245 offset:8704
    s_waitcnt lgkmcnt(4)
    v_mfma_f32_32x32x16_bf16 v[144:159], v[188:191], a[92:95], v[144:159]
    ds_read_b64_tr_b16 v[184:185], v244 offset:9216
    ds_read_b64_tr_b16 v[186:187], v245 offset:9216
    s_waitcnt lgkmcnt(4)
    v_mfma_f32_32x32x16_bf16 v[144:159], v[176:179], a[96:99], v[144:159]
    ds_read_b64_tr_b16 v[188:189], v244 offset:9728
    ds_read_b64_tr_b16 v[190:191], v245 offset:9728
    s_waitcnt lgkmcnt(4)
    v_mfma_f32_32x32x16_bf16 v[144:159], v[180:183], a[100:103], v[144:159]
    ds_read_b64_tr_b16 v[176:177], v246 offset:8192
    ds_read_b64_tr_b16 v[178:179], v247 offset:8192
    s_waitcnt lgkmcnt(4)
    v_mfma_f32_32x32x16_bf16 v[144:159], v[184:187], a[104:107], v[144:159]
    ds_read_b64_tr_b16 v[180:181], v246 offset:8704
    ds_read_b64_tr_b16 v[182:183], v247 offset:8704
    s_waitcnt lgkmcnt(4)
    v_mfma_f32_32x32x16_bf16 v[144:159], v[188:191], a[108:111], v[144:159]
    ds_read_b64_tr_b16 v[184:185], v246 offset:9216
    ds_read_b64_tr_b16 v[186:187], v247 offset:9216
    s_waitcnt lgkmcnt(4)
    v_mfma_f32_32x32x16_bf16 v[144:159], v[176:179], a[112:115], v[144:159]
    ds_read_b64_tr_b16 v[188:189], v246 offset:9728
    ds_read_b64_tr_b16 v[190:191], v247 offset:9728
    s_waitcnt lgkmcnt(4)
    v_mfma_f32_32x32x16_bf16 v[144:159], v[180:183], a[116:119], v[144:159]
    s_cmp_ge_u32 s100, 4
    s_cselect_b32 s45, -1.0, 1.0
    s_cselect_b32 s48, -1, 0
    s_cselect_b32 s49, 513, 0
    s_waitcnt lgkmcnt(2)
    v_mfma_f32_32x32x16_bf16 v[144:159], v[184:187], a[120:123], v[144:159]
    v_xor_b32 v4, s48, v4
    v_add_u32 v4, s49, v4
    v_and_b32 v5, 1, v4
    v_lshlrev_b32 v14, 15, v5
    s_waitcnt lgkmcnt(0)
    v_mfma_f32_32x32x16_bf16 v[144:159], v[188:191], a[124:127], v[144:159]
    s_add_u32 s64, s101, 16384
    buffer_store_dwordx4 v[192:195], v18, s[20:23], s64 offen sc1
    s_add_u32 s64, s101, 81920
    buffer_store_dwordx4 v[196:199], v18, s[20:23], s64 offen sc1
    s_add_u32 s64, s101, 147456
    buffer_store_dwordx4 v[200:203], v18, s[20:23], s64 offen sc1
    s_add_u32 s64, s101, 212992
    buffer_store_dwordx4 v[204:207], v18, s[20:23], s64 offen sc1
    v_swap_b32 v225, v228
    v_swap_b32 v226, v232
    v_swap_b32 v227, v236
    v_swap_b32 v230, v233
    v_swap_b32 v231, v237
    v_swap_b32 v235, v238
    s_add_u32 s64, s101, 540672
    buffer_store_dwordx4 v[224:227], v18, s[20:23], s64 offen sc1
    s_add_u32 s64, s101, 606208
    buffer_store_dwordx4 v[228:231], v18, s[20:23], s64 offen sc1
    s_add_u32 s64, s101, 671744
    buffer_store_dwordx4 v[232:235], v18, s[20:23], s64 offen sc1
    s_add_u32 s64, s101, 737280
    buffer_store_dwordx4 v[236:239], v18, s[20:23], s64 offen sc1
    v_mfma_f32_32x32x16_bf16 v[144:159], v[28:31], v[48:51], v[144:159]
    s_barrier
    v_lshlrev_b32 v17, 4, v1
    s_nop 9
    v_pk_mul_f32 v[176:177], v[144:145], v[144:145]
    v_pk_mul_f32 v[178:179], v[146:147], v[146:147]
    v_pk_mul_f32 v[180:181], v[148:149], v[148:149]
    v_pk_mul_f32 v[182:183], v[150:151], v[150:151]
    v_pk_fma_f32 v[176:177], v[176:177], v[60:61], v[58:59]
    v_pk_fma_f32 v[178:179], v[178:179], v[60:61], v[58:59]
    v_pk_fma_f32 v[180:181], v[180:181], v[60:61], v[58:59]
    v_pk_fma_f32 v[182:183], v[182:183], v[60:61], v[58:59]
    v_pk_mul_f32 v[176:177], v[176:177], v[144:145]
    v_pk_mul_f32 v[178:179], v[178:179], v[146:147]
    v_pk_mul_f32 v[180:181], v[180:181], v[148:149]
    v_pk_mul_f32 v[182:183], v[182:183], v[150:151]
    v_exp_f32 v176, v176
    v_exp_f32 v177, v177
    v_exp_f32 v178, v178
    v_exp_f32 v179, v179
    v_exp_f32 v180, v180
    v_exp_f32 v181, v181
    v_exp_f32 v182, v182
    v_exp_f32 v183, v183
    v_pk_mul_f32 v[144:145], v[144:145], v[152:153]
    v_pk_mul_f32 v[146:147], v[146:147], v[154:155]
    v_pk_mul_f32 v[148:149], v[148:149], v[156:157]
    v_pk_mul_f32 v[150:151], v[150:151], v[158:159]
    v_pk_fma_f32 v[176:177], v[176:177], v[62:63], v[62:63]
    v_pk_fma_f32 v[178:179], v[178:179], v[62:63], v[62:63]
    v_pk_fma_f32 v[180:181], v[180:181], v[62:63], v[62:63]
    v_pk_fma_f32 v[182:183], v[182:183], v[62:63], v[62:63]
    v_rcp_f32 v176, v176
    v_rcp_f32 v177, v177
    v_rcp_f32 v178, v178
    v_rcp_f32 v179, v179
    v_rcp_f32 v180, v180
    v_rcp_f32 v181, v181
    v_rcp_f32 v182, v182
    v_rcp_f32 v183, v183
    s_nop 0
    v_pk_mul_f32 v[144:145], v[144:145], v[176:177]
    v_pk_mul_f32 v[146:147], v[146:147], v[178:179]
    v_pk_mul_f32 v[148:149], v[148:149], v[180:181]
    v_pk_mul_f32 v[150:151], v[150:151], v[182:183]
    v_cvt_pk_bf16_f32 v184, v144, v145
    v_cvt_pk_bf16_f32 v185, v146, v147
    v_cvt_pk_bf16_f32 v186, v148, v149
    v_cvt_pk_bf16_f32 v187, v150, v151
    buffer_store_dwordx4 v[184:187], v17, s[20:23], s55 offen sc1
    s_xor_b32 s97, s94, 3
    s_add_u32 m0, s93, 49152
    s_lshl_b32 s96, s97, 16
    s_add_u32 s96, s96, s92
    buffer_load_dwordx4 v8, s[4:7], s96 offen lds
    v_bfe_u32 v5, v4, 6, 2
    v_lshl_add_u32 v14, v5, 13, v14
    v_bfe_u32 v5, v4, 1, 5
    v_lshl_add_u32 v14, v5, 4, v14
    v_lshl_add_u32 v14, v3, 9, v14
    s_xor_b32 s36, s99, s48
    s_add_u32 s36, s36, s49
    s_and_b32 s36, s36, 31
    s_lshl_b32 s46, s36, 16
    buffer_load_dwordx4 v9, s[4:7], s96 offen offset:1024 lds
    s_add_u32 s46, s46, 6291456
    s_lshl_b32 s36, s41, 12
    s_add_u32 s46, s46, s36
    v_lshlrev_b32 v27, 16, v2
    v_lshl_add_u32 v27, v3, 4, v27
    s_lshl_b32 s47, s42, 10
    s_lshl_b32 s36, s41, 6
    s_add_u32 s47, s47, s36
    s_lshl_b32 s36, s100, 7
    buffer_load_dwordx4 v10, s[4:7], s96 offen offset:2048 lds
    s_add_u32 s47, s47, s36
    v_lshl_add_u32 v26, v2, 6, s42
    v_bfe_u32 v4, v1, 1, 3
    v_lshlrev_b32 v4, 4, v4
    v_lshl_add_u32 v4, v2, 7, v4
    v_lshl_add_u32 v4, v3, 3, v4
    s_lshl_b32 s36, s41, 6
    v_xor_b32 v4, s36, v4
    s_lshl_b32 s36, s40, 12
    buffer_load_dwordx4 v11, s[4:7], s96 offen offset:3072 lds
    s_add_u32 s36, s36, 147456
    v_add_u32 v15, s36, v4
    v_bfe_u32 v4, v1, 2, 2
    v_lshlrev_b32 v12, 7, v4
    v_lshl_add_u32 v12, v3, 9, v12
    v_and_b32 v4, 3, v1
    v_lshl_add_u32 v12, v4, 3, v12
    v_bfe_u32 v4, v1, 4, 1
    v_lshl_add_u32 v12, v4, 5, v12
    s_xor_b32 s97, s94, 4
    s_add_u32 m0, s93, 65536
    s_lshl_b32 s96, s97, 16
    s_add_u32 s96, s96, s92
    buffer_load_dwordx4 v8, s[4:7], s96 offen lds
    v_bfe_u32 v4, v1, 3, 1
    v_lshl_add_u32 v12, v4, 6, v12
    s_mul_i32 s36, s41, 8256
    v_xor_b32 v12, s36, v12
    v_xor_b32 v13, 64, v12
    v_add_u32 v20, 65536, v12
    v_add_u32 v21, 65536, v13
    s_lshl_b32 s36, s41, 5
    v_lshl_add_u32 v4, v3, 2, s36
    buffer_load_dwordx4 v9, s[4:7], s96 offen offset:1024 lds
    v_mul_u32_u24 v4, v4, v26
    v_lshlrev_b32 v5, 2, v26
    s_mov_b32 s52, 0x3a000000
    s_lshl_b32 s36, s32, 12
    s_add_u32 s36, s36, 131072
    v_add_u32 v52, s36, v6
    v_and_b32 v22, 2047, v4
    v_add_u32 v4, v4, v26
    v_cvt_f32_u32 v22, v22
    buffer_load_dwordx4 v10, s[4:7], s96 offen offset:2048 lds
    v_mul_f32 v22, s52, v22
    v_sin_f32 v23, v22
    v_cos_f32 v22, v22
    v_mul_f32 v23, s45, v23
    v_cvt_pk_bf16_f32 v64, v22, v23
    v_and_b32 v24, 2047, v4
    v_add_u32 v4, v4, v26
    v_cvt_f32_u32 v24, v24
    v_mul_f32 v24, s52, v24
    buffer_load_dwordx4 v11, s[4:7], s96 offen offset:3072 lds
    v_sin_f32 v25, v24
    v_cos_f32 v24, v24
    v_mul_f32 v25, s45, v25
    v_cvt_pk_bf16_f32 v65, v24, v25
    v_and_b32 v22, 2047, v4
    v_add_u32 v4, v4, v26
    v_cvt_f32_u32 v22, v22
    v_mul_f32 v22, s52, v22
    v_sin_f32 v23, v22
    s_waitcnt vmcnt(8)
    s_barrier
    s_cmp_lg_u32 s32, 0
    s_cbranch_scc1 L_df1
    v_mov_b32 v17, s95
    s_mov_b64 exec, 1
    buffer_store_dword v17, off, s[20:23], s98 sc1
    buffer_store_dword v17, off, s[20:23], s3 sc1
    s_mov_b64 exec, -1
L_df1:
    s_xor_b32 s97, s94, 5
    s_add_u32 m0, s93, 81920
    s_lshl_b32 s96, s97, 16
    s_add_u32 s96, s96, s92
    buffer_load_dwordx4 v8, s[4:7], s96 offen lds
    v_cos_f32 v22, v22
    v_mul_f32 v23, s45, v23
    v_cvt_pk_bf16_f32 v66, v22, v23
    v_and_b32 v24, 2047, v4
    v_add_u32 v4, v4, v26
    v_cvt_f32_u32 v24, v24
    v_mul_f32 v24, s52, v24
    v_sin_f32 v25, v24
    v_cos_f32 v24, v24
    buffer_load_dwordx4 v9, s[4:7], s96 offen offset:1024 lds
    v_mul_f32 v25, s45, v25
    v_cvt_pk_bf16_f32 v67, v24, v25
    v_add_u32 v4, v4, v5
    ds_write_b128 v52, v[64:67] offset:0
    v_and_b32 v22, 2047, v4
    v_add_u32 v4, v4, v26
    v_cvt_f32_u32 v22, v22
    v_mul_f32 v22, s52, v22
    v_sin_f32 v23, v22
    buffer_load_dwordx4 v10, s[4:7], s96 offen offset:2048 lds
    v_cos_f32 v22, v22
    v_mul_f32 v23, s45, v23
    v_cvt_pk_bf16_f32 v68, v22, v23
    v_and_b32 v24, 2047, v4
    v_add_u32 v4, v4, v26
    v_cvt_f32_u32 v24, v24
    v_mul_f32 v24, s52, v24
    v_sin_f32 v25, v24
    v_cos_f32 v24, v24
    buffer_load_dwordx4 v11, s[4:7], s96 offen offset:3072 lds
    v_mul_f32 v25, s45, v25
    v_cvt_pk_bf16_f32 v69, v24, v25
    v_and_b32 v22, 2047, v4
    v_add_u32 v4, v4, v26
    v_cvt_f32_u32 v22, v22
    v_mul_f32 v22, s52, v22
    v_sin_f32 v23, v22
    v_cos_f32 v22, v22
    v_mul_f32 v23, s45, v23
    s_xor_b32 s97, s94, 6
    s_add_u32 m0, s93, 98304
    s_lshl_b32 s96, s97, 16
    s_add_u32 s96, s96, s92
    buffer_load_dwordx4 v8, s[4:7], s96 offen lds
    v_cvt_pk_bf16_f32 v70, v22, v23
    v_and_b32 v24, 2047, v4
    v_add_u32 v4, v4, v26
    v_cvt_f32_u32 v24, v24
    v_mul_f32 v24, s52, v24
    v_sin_f32 v25, v24
    v_cos_f32 v24, v24
    v_mul_f32 v25, s45, v25
    v_cvt_pk_bf16_f32 v71, v24, v25
    buffer_load_dwordx4 v9, s[4:7], s96 offen offset:1024 lds
    v_add_u32 v4, v4, v5
    ds_write_b128 v52, v[68:71] offset:1024
    v_and_b32 v22, 2047, v4
    v_add_u32 v4, v4, v26
    v_cvt_f32_u32 v22, v22
    v_mul_f32 v22, s52, v22
    v_sin_f32 v23, v22
    v_cos_f32 v22, v22
    v_mul_f32 v23, s45, v23
    buffer_load_dwordx4 v10, s[4:7], s96 offen offset:2048 lds
    v_cvt_pk_bf16_f32 v72, v22, v23
    v_and_b32 v24, 2047, v4
    v_add_u32 v4, v4, v26
    v_cvt_f32_u32 v24, v24
    v_mul_f32 v24, s52, v24
    v_sin_f32 v25, v24
    v_cos_f32 v24, v24
    v_mul_f32 v25, s45, v25
    v_cvt_pk_bf16_f32 v73, v24, v25
    buffer_load_dwordx4 v11, s[4:7], s96 offen offset:3072 lds
    v_and_b32 v22, 2047, v4
    v_add_u32 v4, v4, v26
    v_cvt_f32_u32 v22, v22
    v_mul_f32 v22, s52, v22
    v_sin_f32 v23, v22
    v_cos_f32 v22, v22
    v_mul_f32 v23, s45, v23
    v_cvt_pk_bf16_f32 v74, v22, v23
    v_and_b32 v24, 2047, v4
    s_xor_b32 s97, s94, 7
    s_add_u32 m0, s93, 114688
    s_lshl_b32 s96, s97, 16
    s_add_u32 s96, s96, s92
    buffer_load_dwordx4 v8, s[4:7], s96 offen lds
    v_add_u32 v4, v4, v26
    v_cvt_f32_u32 v24, v24
    v_mul_f32 v24, s52, v24
    v_sin_f32 v25, v24
    v_cos_f32 v24, v24
    v_mul_f32 v25, s45, v25
    v_cvt_pk_bf16_f32 v75, v24, v25
    v_add_u32 v4, v4, v5
    ds_write_b128 v52, v[72:75] offset:2048
    buffer_load_dwordx4 v9, s[4:7], s96 offen offset:1024 lds
    v_and_b32 v22, 2047, v4
    v_add_u32 v4, v4, v26
    v_cvt_f32_u32 v22, v22
    v_mul_f32 v22, s52, v22
    v_sin_f32 v23, v22
    v_cos_f32 v22, v22
    v_mul_f32 v23, s45, v23
    v_cvt_pk_bf16_f32 v76, v22, v23
    v_and_b32 v24, 2047, v4
    buffer_load_dwordx4 v10, s[4:7], s96 offen offset:2048 lds
    v_add_u32 v4, v4, v26
    v_cvt_f32_u32 v24, v24
    v_mul_f32 v24, s52, v24
    v_sin_f32 v25, v24
    v_cos_f32 v24, v24
    v_mul_f32 v25, s45, v25
    v_cvt_pk_bf16_f32 v77, v24, v25
    v_and_b32 v22, 2047, v4
    v_add_u32 v4, v4, v26
    buffer_load_dwordx4 v11, s[4:7], s96 offen offset:3072 lds
    v_cvt_f32_u32 v22, v22
    v_mul_f32 v22, s52, v22
    v_sin_f32 v23, v22
    v_cos_f32 v22, v22
    v_mul_f32 v23, s45, v23
    v_cvt_pk_bf16_f32 v78, v22, v23
    v_and_b32 v24, 2047, v4
    v_add_u32 v4, v4, v26
    v_cvt_f32_u32 v24, v24
    v_mul_f32 v24, s52, v24
    v_sin_f32 v25, v24
    v_cos_f32 v24, v24
    v_mul_f32 v25, s45, v25
    v_cvt_pk_bf16_f32 v79, v24, v25
    v_add_u32 v4, v4, v5
    ds_write_b128 v52, v[76:79] offset:3072
    v_lshrrev_b32 v5, 4, v1
    v_and_b32 v4, 7, v1
    v_xor_b32 v4, v4, v5
    v_lshlrev_b32 v4, 4, v4
    v_lshrrev_b32 v5, 3, v1
    v_lshl_add_u32 v4, v5, 16, v4
    v_xor_b32 v5, 64, v4
    v_add_u32 v5, 523264, v5
    s_lshr_b32 s36, s32, 1
    s_lshl_b32 s36, s36, 5
    s_add_u32 s36, s36, s99
    s_lshl_b32 s36, s36, 10
    s_and_b32 s37, s32, 1
    s_lshl_b32 s37, s37, 20
    s_add_u32 s36, s36, s37
    s_lshl_b32 s37, s100, 7
    s_add_u32 s36, s36, s37
    s_lshl_b32 s37, s32, 11
    s_add_u32 m0, s37, 147456
    s_nop 0
    buffer_load_dwordx4 v4, s[8:11], s36 offen lds
    buffer_load_dwordx4 v5, s[8:11], s36 offen offset:1024 lds
    s_branch L_join
L_code_end:
.section .rodata,"a"
.p2align 6
.amdhsa_kernel recurrent_scan__spectral_fnet__geglu_ffn__prompt_kernel
  .amdhsa_next_free_vgpr 512
  .amdhsa_next_free_sgpr 102
  .amdhsa_accum_offset 256
  .amdhsa_group_segment_fixed_size 0
  .amdhsa_kernarg_size 96
  .amdhsa_user_sgpr_count 2
  .amdhsa_user_sgpr_kernarg_segment_ptr 1
  .amdhsa_system_sgpr_workgroup_id_x 1
  .amdhsa_float_denorm_mode_32 3
.end_amdhsa_kernel
```
